```python
import torch

def _softmax(x, axis=-1):
    return torch.softmax(x, dim=axis)
def _gelu(x):
    return torch.nn.functional.gelu(x, approximate="tanh")
def _silu(x):
    return torch.nn.functional.silu(x)
def _sigmoid(x):
    return torch.sigmoid(x)
def _layernorm(x, axis=-1, eps=1e-5):
    m = x.mean(dim=axis, keepdim=True)
    v = x.var(dim=axis, keepdim=True, unbiased=False)
    return (x - m) / torch.sqrt(v + eps)
def _scatter_add(tgt, idx, src, axis=0):
    return tgt.clone().index_add_(axis, idx, src)
def _segment_sum(src, seg, n):
    out = torch.zeros((n,) + src.shape[1:], dtype=src.dtype)
    return out.index_add_(0, seg, src)
def _pad(x, pw):
    flat = tuple(v for pair in reversed(pw) for v in pair)
    return torch.nn.functional.pad(x, flat)

kernel_name = 'parallel_sum__ssm_conv_h3__mixer_channel_mlp__prompt'

def setup_inputs():

    _w = (lambda a: (lambda t: t.to(torch.bfloat16) if t.is_floating_point() else t)(torch.as_tensor(a)))
    def _A_setup():
        B, S, D = 1, 2048, 512
        ks = 4
        return {
            "q": _w((lambda *s: torch.randn(*s, dtype=torch.bfloat16) * 0.05)(B, S, D)),
            "k": _w((lambda *s: torch.randn(*s, dtype=torch.bfloat16) * 0.2)(B, S, D)),
            "v": _w((lambda *s: torch.randn(*s, dtype=torch.bfloat16) * 0.2)(B, S, D)),
            "shift_k": _w((lambda *s: torch.randn(*s, dtype=torch.bfloat16) * 0.2)(D, ks) * 0.5),
            "ssm_k": _w((lambda *s: torch.randn(*s, dtype=torch.bfloat16) * 0.8)(D, S) * (1.0 / S ** 0.5)),
            "ssm_D": _w((lambda *s: torch.randn(*s, dtype=torch.bfloat16) * 0.2)(D)),
        }
    _A_in = _A_setup()

    def _B_setup():
        B, S, D, F = 1, 2048, 512, 1792
        return {
            "x": _w((lambda *s: torch.randn(*s, dtype=torch.bfloat16) * 0.05)(B, S, D)),
            "w1": _w((lambda *s: torch.randn(*s, dtype=torch.bfloat16) * 0.8)(D, F) * (D ** -0.5)),
            "b1": _w((lambda *s: torch.randn(*s, dtype=torch.bfloat16) * 0.4)(F)),
            "w2": _w((lambda *s: torch.randn(*s, dtype=torch.bfloat16) * 0.05)(F, D) * (F ** -0.5)),
            "b2": _w((lambda *s: torch.randn(*s, dtype=torch.bfloat16) * 0.05)(D)),
        }
    _B_in = _B_setup()

    return {
        "A_q": _A_in["q"],
        "A_k": _A_in["k"],
        "A_v": _A_in["v"],
        "A_shift_k": _A_in["shift_k"],
        "A_ssm_k": _A_in["ssm_k"],
        "A_ssm_D": _A_in["ssm_D"],
        "B_x": _B_in["x"],
        "B_w1": _B_in["w1"],
        "B_b1": _B_in["b1"],
        "B_w2": _B_in["w2"],
        "B_b2": _B_in["b2"],
    }

def reference(A_q, A_k, A_v, A_shift_k, A_ssm_k, A_ssm_D, B_x, B_w1, B_b1, B_w2, B_b2):
    def _A_ref(q, k, v, shift_k, ssm_k, ssm_D):
        B, S, D = q.shape
        ks = shift_k.shape[-1]
        k_pad = _pad(k, ((0, 0), (ks - 1, 0), (0, 0)))
        k_shift = torch.zeros_like(k)
        for t in range(ks):
            k_shift = k_shift + k_pad[:, t:t + S, :] * shift_k[:, ks - 1 - t][None, None, :]
        kv = k_shift * v
        L = 2 * S
        kv_pad = _pad(kv, ((0, 0), (0, S), (0, 0)))
        kf_pad = _pad(ssm_k, ((0, 0), (0, S)))
        kv_f = (lambda x, axes=(-2,-1): torch.fft.rfft2(x.float(), dim=axes))(kv_pad[:, None, :, :], axes=(1, 2))
        kf_f = (lambda x, axes=(-2,-1): torch.fft.rfft2(x.float(), dim=axes))(kf_pad[:, None, :], axes=(1, 2))
        kf_f = (lambda x, *d: x.permute(*d))(kf_f, 1, 2, 0)
        y_f = kv_f * kf_f[None, :, :, :]
        y = (lambda x, s, axes=(-2,-1): torch.fft.irfft2(x, s=s, dim=axes).to(torch.bfloat16))(y_f, (1, L), axes=(1, 2))[:, 0, :S, :]
        y = y + kv * ssm_D[None, None, :]
        return q * y

    def _B_ref(x, w1, b1, w2, b2):
        y = _layernorm(x, axis=-1)
        h = _gelu(torch.einsum("bsd,df->bsf", y, w1) + b1)
        return torch.einsum("bsf,fd->bsd", h, w2) + b2

    x = A_q
    xn = _layernorm(x, axis=-1)
    return x + _A_ref(xn, A_k, A_v, A_shift_k, A_ssm_k, A_ssm_D) + _B_ref(xn, B_w1, B_b1, B_w2, B_b2)
```

```asm
; @launch grid=(256,1,1) block=(256,1,1) lds=163840
.amdgcn_target "amdgcn-amd-amdhsa--gfx950"
.text
.globl parallel_sum__ssm_conv_h3__mixer_channel_mlp__prompt_kernel
.p2align 8
.type parallel_sum__ssm_conv_h3__mixer_channel_mlp__prompt_kernel,@function
parallel_sum__ssm_conv_h3__mixer_channel_mlp__prompt_kernel:
    s_cmp_ge_u32 s2, 0x100
    s_cbranch_scc1 Lend
    s_load_dwordx16 s[16:31], s[0:1], 0
    s_load_dwordx8 s[32:39], s[0:1], 64
    s_load_dwordx4 s[40:43], s[0:1], 96
    v_lshrrev_b32 v190, 6, v0
    s_getpc_b64 s[4:5]
Lpc:
    v_readfirstlane_b32 s3, v190
    v_and_b32 v0, 63, v0
    s_and_b32 s8, s2, 7
    s_lshr_b32 s9, s2, 3
    s_lshl2_add_u32 s14, s9, s3
    s_lshl_b32 s15, s14, 8
    v_lshrrev_b32 v191, 5, v0
    v_lshl_add_u32 v190, v191, 7, s15
    v_min_u32 v190, Lcode_end-Lpc-4, v190
    global_load_dword a223, v190, s[4:5]
    s_and_b32 s88, s8, 1
    s_mul_i32 s15, s9, 37
    s_lshr_b32 s15, s15, 8
    s_mul_i32 s98, s15, 7
    s_sub_u32 s11, s9, s98
    s_mul_i32 s98, s88, 7
    s_add_u32 s11, s11, s98
    s_min_u32 s15, s15, 3
    s_lshr_b32 s10, s8, 1
    s_lshl2_add_u32 s12, s10, s15
    s_cmp_ge_u32 s9, 28
    s_cselect_b32 s77, 0x40000000, 0
    v_lshrrev_b32 v188, 3, v0
    v_and_b32 v189, 7, v0
    v_lshrrev_b32 v185, 4, v0
    v_and_b32 v187, 3, v0
    v_lshlrev_b32 v1, 4, v0
    v_lshlrev_b32 v2, 3, v0
    s_lshl_b32 s100, s3, 12
    s_and_b32 s99, s3, 1
    s_mul_i32 s15, s99, 114688
    s_lshr_b32 s98, s3, 1
    s_lshl1_add_u32 s98, s11, s98
    s_lshl_b32 s98, s98, 7
    s_add_u32 s15, s15, s98
    s_add_u32 s15, s15, s77
    s_movk_i32 s85, 3584
    v_mul_u32_u24 v190, s85, v188
    v_and_b32 v192, 1, v185
    v_lshlrev_b32 v192, 1, v192
    v_xor_b32 v192, v189, v192
    v_lshl_add_u32 v190, v192, 4, v190
    v_add_u32 v17, s15, v190
    v_xor_b32 v190, 64, v17
    v_add_u32 v18, 27648, v190
    v_add_u32 v19, 55296, v17
    v_add_u32 v20, 55296, v18
    s_lshl2_add_u32 s98, s12, s3
    s_lshl_b32 s98, s98, 15
    s_add_u32 s98, s98, s77
    v_xor_b32 v190, v189, v185
    v_lshlrev_b32 v190, 4, v190
    v_lshl_add_u32 v190, v188, 10, v190
    v_add_u32 v11, s98, v190
    v_xor_b32 v190, 64, v11
    v_add_u32 v12, 7168, v190
    v_add_u32 v13, 14336, v11
    v_add_u32 v14, 14336, v12
    s_movk_i32 s97, 0x2000
    v_mov_b32 v193, 0x80000000
    s_lshl_b32 s15, s14, 14
    s_lshl_b32 s98, s8, 7
    s_add_u32 s15, s15, s98
    v_lshl_add_u32 v190, v188, 10, s15
    v_lshl_add_u32 v245, v189, 4, v190
    v_cmp_gt_u32 vcc, 32, v0
    v_subrev_u32 v244, s97, v245
    s_lshl_b32 s15, s8, 9
    v_add_u32 v247, s15, v2
    v_cndmask_b32 v244, v244, v193, vcc
    s_mul_i32 s86, s3, 5120
    s_add_u32 s86, s86, 131072
    s_add_u32 s99, s98, s14
    s_lshl_b32 s98, s99, 11
    s_lshl_b32 s15, s10, 7
    s_add_u32 s15, s15, s14
    s_lshl1_add_u32 s15, s15, s88
    s_mul_i32 s84, s15, 1792
    v_min_u32 v190, 13, v0
    v_lshlrev_b32 v6, 7, v190
    s_waitcnt lgkmcnt(0)
    s_mov_b32 s56, s30
    s_and_b32 s57, s31, 0xffff
    s_mov_b32 s58, 1835008
    s_mov_b32 s59, 0x20000
    s_add_u32 m0, s100, 0
    s_mov_b32 s80, 0
    buffer_load_dwordx4 v17, s[56:59], s80 offen offset:0 lds
    buffer_load_dwordx4 v18, s[56:59], s80 offen offset:1024 lds
    buffer_load_dwordx4 v19, s[56:59], s80 offen offset:2048 lds
    buffer_load_dwordx4 v20, s[56:59], s80 offen offset:3072 lds
    s_mov_b32 s44, s16
    s_and_b32 s45, s17, 0xffff
    s_mov_b32 s46, 2097152
    s_mov_b32 s47, 0x20000
    buffer_load_dwordx4 v[112:115], v1, s[44:47], s98 offen
    buffer_load_dwordx4 v[116:119], v1, s[44:47], s98 offen offset:1024
    s_add_u32 m0, s100, 16384
    s_movk_i32 s76, 0
    buffer_load_dwordx4 v11, s[44:47], s76 offen offset:0 lds
    buffer_load_dwordx4 v12, s[44:47], s76 offen offset:1024 lds
    buffer_load_dwordx4 v13, s[44:47], s76 offen offset:2048 lds
    buffer_load_dwordx4 v14, s[44:47], s76 offen offset:3072 lds
    buffer_load_dword a223, v6, s[56:59], s84 offen
    s_mov_b32 s72, s40
    s_and_b32 s73, s41, 0xffff
    s_mov_b32 s74, 8
    s_mov_b32 s75, 0x20000
    s_andn2_b32 s15, s99, 3
    s_load_dword s94, s[26:27], s15
    s_memrealtime s[6:7]
    v_cmp_eq_u32 vcc, 0, v0
    s_or_b32 s98, s2, s3
    s_cmp_eq_u32 s98, 0
    s_cselect_b32 s98, 0, 64
    v_cndmask_b32_e64 v3, v193, 0, vcc
    s_mov_b32 s68, s42
    s_and_b32 s69, s43, 0xffff
    s_mov_b32 s70, 12582912
    s_mov_b32 s71, 0x20000
    s_mov_b32 s60, s34
    s_and_b32 s61, s35, 0xffff
    s_mov_b32 s62, 1835008
    s_mov_b32 s63, 0x20000
    v_and_b32 v184, 15, v0
    v_bfe_u32 v186, v0, 2, 2
    v_lshlrev_b32 v10, 4, v184
    v_lshlrev_b32 v190, 7, v186
    v_lshl_add_u32 v190, v185, 5, v190
    v_lshl_add_u32 v190, v187, 3, v190
    v_add_u32 v246, s86, v190
    v_lshl_add_u32 v190, v185, 3, v186
    v_lshlrev_b32 v190, 7, v190
    v_lshl_add_u32 v190, v187, 3, v190
    v_bfe_u32 v192, v0, 3, 2
    v_lshl_add_u32 v190, v192, 5, v190
    v_add_u32 v21, s100, v190
    v_xor_b32 v22, 32, v21
    v_xor_b32 v23, 64, v21
    v_xor_b32 v24, 96, v21
    v_xor_b32 v25, 4096, v21
    v_xor_b32 v26, 4128, v21
    v_xor_b32 v27, 4160, v21
    v_xor_b32 v28, 4192, v21
    s_and_b32 s15, s3, 1
    s_lshl_b32 s90, s15, 2
    s_lshl_b32 s15, s15, 13
    s_add_u32 s15, s15, 16384
    v_lshrrev_b32 v190, 1, v184
    v_xor_b32 v190, v190, v185
    v_xor_b32 v190, s90, v190
    v_lshlrev_b32 v190, 4, v190
    v_lshl_add_u32 v190, v184, 7, v190
    v_add_u32 v15, s15, v190
    v_xor_b32 v16, 64, v15
    s_waitcnt lgkmcnt(0)
    s_or_b32 s15, s6, 1
    v_mov_b32 v4, s15
    v_mov_b32 v5, s7
    buffer_store_dwordx2 v[4:5], v3, s[72:75], s98 offen sc1
    s_and_b32 s95, s94, 0xffff0000
    s_lshl_b32 s94, s94, 16
    s_lshl_b32 s15, s10, 7
    s_add_u32 s15, s15, s14
    s_mul_i32 s15, s15, 14
    v_min_u32 v190, 13, v0
    v_add_u32 v190, s15, v190
    v_lshrrev_b32 v191, 2, v190
    v_and_b32 v190, 3, v190
    v_lshlrev_b32 v190, 7, v190
    s_lshl_b32 s15, s88, 9
    v_lshl_add_u32 v190, v191, 10, v190
    v_add_u32 v7, s15, v190
    v_mov_b32 v191, 0x3f803f80
    v_cmp_eq_u32 vcc, 0, v184
    s_nop 1
    v_cndmask_b32 v192, 0, v191, vcc
    v_accvgpr_write_b32 a224, v192
    v_accvgpr_write_b32 a225, v192
    v_accvgpr_write_b32 a226, v192
    v_accvgpr_write_b32 a227, v192
    v_cmp_eq_u32 vcc, 1, v184
    s_nop 1
    v_cndmask_b32 v192, 0, v191, vcc
    v_accvgpr_write_b32 a228, v192
    v_accvgpr_write_b32 a229, v192
    v_accvgpr_write_b32 a230, v192
    v_accvgpr_write_b32 a231, v192
    v_cmp_eq_u32 vcc, 2, v184
    s_nop 1
    v_cndmask_b32 v192, 0, v191, vcc
    v_accvgpr_write_b32 a232, v192
    v_accvgpr_write_b32 a233, v192
    v_accvgpr_write_b32 a234, v192
    v_accvgpr_write_b32 a235, v192
    v_cmp_eq_u32 vcc, 3, v184
    s_nop 1
    v_cndmask_b32 v192, 0, v191, vcc
    v_accvgpr_write_b32 a236, v192
    v_accvgpr_write_b32 a237, v192
    v_accvgpr_write_b32 a238, v192
    v_accvgpr_write_b32 a239, v192
    s_mov_b32 s48, s18
    s_and_b32 s49, s19, 0xffff
    s_mov_b32 s50, 2097152
    s_mov_b32 s51, 0x20000
    s_mov_b32 m0, s86
    s_mov_b32 s52, s20
    buffer_load_dwordx4 v244, s[48:51], 0 offen lds
    global_load_dwordx2 v[248:249], v247, s[22:23]
    s_and_b32 s53, s21, 0xffff
    s_mov_b32 s54, 2097152
    s_mov_b32 s55, 0x20000
    s_add_u32 m0, s86, 1024
    s_lshl_b32 s21, s99, 5
    buffer_load_dwordx4 v245, s[48:51], 0 offen lds
    s_add_u32 m0, s86, 2048
    s_add_u32 s21, s21, 393216
    buffer_load_dwordx4 v245, s[48:51], s97 offen lds
    s_add_u32 m0, s86, 3072
    s_nop 0
    buffer_load_dwordx4 v245, s[52:55], 0 offen lds
    s_add_u32 m0, s86, 4096
    s_nop 0
    buffer_load_dwordx4 v245, s[52:55], s97 offen lds
    s_add_u32 m0, s100, 32768
    s_mov_b32 s80, 229376
    buffer_load_dwordx4 v17, s[56:59], s80 offen offset:0 lds
    s_lshl_b32 s15, s3, 11
    buffer_load_dwordx4 v18, s[56:59], s80 offen offset:1024 lds
    s_add_u32 s98, s15, 151552
    v_add_u32 v45, s98, v1
    v_xor_b32 v190, v189, v188
    v_lshlrev_b32 v190, 4, v190
    v_lshl_add_u32 v46, v188, 12, v190
    s_add_u32 s15, s15, 114688
    v_lshl_add_u32 v47, v185, 4, s15
    v_lshl_add_u32 v48, v184, 6, v47
    s_sub_u32 s15, 3, s3
    s_lshl_b32 s15, s15, 1
    v_xor_b32 v190, s15, v189
    v_lshlrev_b32 v190, 4, v190
    v_lshl_add_u32 v190, v0, 7, v190
    v_add_u32 v44, 151552, v190
    s_lshl2_add_u32 s20, s8, s3
    buffer_load_dwordx4 v19, s[56:59], s80 offen offset:2048 lds
    s_lshl_b32 s20, s20, 16
    s_lshl_b32 s98, s9, 7
    s_sub_u32 s20, s20, s98
    s_add_u32 s20, s20, 1052544
    v_and_b32 v190, 31, v0
    v_cmp_eq_u32 vcc, 0, v190
    v_lshrrev_b32 v190, 1, v0
    s_nop 0
    v_cndmask_b32 v49, v193, v190, vcc
    s_lshr_b32 s15, s9, 3
    s_lshl2_add_u32 s10, s10, s15
    buffer_load_dwordx4 v20, s[56:59], s80 offen offset:3072 lds
    s_and_b32 s101, s9, 1
    s_bfe_u32 s13, s9, 0x20001
    s_lshl2_add_u32 s13, s88, s13
    s_lshl_b32 s98, s8, 7
    s_add_u32 s98, s98, s14
    s_lshl_b32 s28, s98, 11
    s_add_u32 s31, s28, 1048576
    s_add_u32 s28, s28, 3145728
    s_lshl_b32 s34, s98, 7
    s_add_u32 s42, s34, 262144
    s_lshr_b32 s98, s98, 1
    s_lshl_b32 s98, s98, 12
    s_add_u32 s64, s24, s98
    s_addc_u32 s65, s25, 0
    s_and_b32 s65, s65, 0xffff
    s_movk_i32 s66, 0x1000
    s_mov_b32 s67, 0x20000
    s_mul_i32 s15, s3, 458752
    s_lshl_b32 s98, s13, 7
    s_add_u32 s15, s15, s98
    v_lshlrev_b32 v190, 1, v185
    v_xor_b32 v190, v189, v190
    v_lshlrev_b32 v190, 4, v190
    v_lshl_add_u32 v190, v188, 10, v190
    v_add_u32 v30, s15, v190
    s_add_u32 m0, s100, 49152
    s_movk_i32 s76, 128
    buffer_load_dwordx4 v11, s[44:47], s76 offen offset:0 lds
    v_add_u32 v31, 7168, v30
    v_add_u32 v32, 14336, v30
    v_add_u32 v33, 21504, v30
    s_and_b32 s99, s3, 1
    buffer_load_dwordx4 v12, s[44:47], s76 offen offset:1024 lds
    s_lshl_b32 s99, s99, 11
    v_add_u32 v43, s99, v1
    v_subrev_u32 v250, 4, v43
    v_add_u32 v251, 1020, v43
    s_lshr_b32 s15, s3, 1
    s_lshl1_add_u32 s84, s11, s15
    s_lshl_b32 s98, s84, 7
    v_min_u32 v190, 3, v184
    v_lshl_add_u32 v190, v190, 5, s98
    v_lshl_add_u32 v50, v185, 3, v190
    s_mov_b32 s15, 0x3f803f80
    buffer_load_dwordx4 v13, s[44:47], s76 offen offset:2048 lds
    s_waitcnt vmcnt(20)
    v_dot2_f32_bf16 v120, v112, s15, 0
    v_dot2_f32_bf16 v122, v112, v112, 0
    s_waitcnt vmcnt(19)
    v_dot2_f32_bf16 v121, v116, s15, 0
    v_dot2_f32_bf16 v123, v116, v116, 0
    v_dot2_f32_bf16 v120, v113, s15, v120
    v_dot2_f32_bf16 v122, v113, v113, v122
    v_dot2_f32_bf16 v121, v117, s15, v121
    v_dot2_f32_bf16 v123, v117, v117, v123
    v_dot2_f32_bf16 v120, v114, s15, v120
    v_dot2_f32_bf16 v122, v114, v114, v122
    v_dot2_f32_bf16 v121, v118, s15, v121
    v_dot2_f32_bf16 v123, v118, v118, v123
    v_dot2_f32_bf16 v120, v115, s15, v120
    v_dot2_f32_bf16 v122, v115, v115, v122
    v_dot2_f32_bf16 v121, v119, s15, v121
    v_dot2_f32_bf16 v123, v119, v119, v123
    buffer_load_dwordx4 v14, s[44:47], s76 offen offset:3072 lds
    s_nop 0
    v_permlane32_swap_b32 v120, v121
    v_permlane32_swap_b32 v122, v123
    v_add_f32 v120, v120, v121
    v_add_f32 v122, v122, v123
    s_waitcnt vmcnt(16)
    s_barrier
    ds_read_b128 v[152:155], v15 offset:0
    v_permlane16_swap_b32 v120, v122
    v_add_f32 v120, v120, v122
    buffer_load_dwordx2 v[4:5], off, s[72:75], 0 sc1
    s_nop 0
    v_add_f32_dpp v120, v120, v120 row_ror:8 row_mask:0xf bank_mask:0xf
    ds_read_b128 v[156:159], v15 offset:2048
    s_nop 0
    v_add_f32_dpp v120, v120, v120 row_ror:4 row_mask:0xf bank_mask:0xf
    ds_read_b64_tr_b16 v[56:57], v21 offset:0
    s_nop 0
    v_add_f32_dpp v120, v120, v120 row_ror:2 row_mask:0xf bank_mask:0xf
    ds_read_b64_tr_b16 v[58:59], v21 offset:512
    s_nop 0
    v_add_f32_dpp v120, v120, v120 row_ror:1 row_mask:0xf bank_mask:0xf
    v_mov_b32 v121, v120
    ds_read_b128 v[160:163], v15 offset:4096
    s_nop 0
    v_permlane16_swap_b32 v120, v121
    v_mul_f32 v236, 0x3b000000, v120
    v_mul_f32 v121, 0x3b000000, v121
    v_fma_f32 v121, -v236, v236, v121
    v_max_f32 v121, 0, v121
    v_add_f32 v121, 0x3727c5ac, v121
    v_rsq_f32 v237, v121
    ds_read_b128 v[164:167], v15 offset:6144
    ds_read_b64_tr_b16 v[60:61], v22 offset:0
    ds_read_b64_tr_b16 v[62:63], v22 offset:512
    ds_read_b64_tr_b16 v[64:65], v23 offset:0
    ds_read_b64_tr_b16 v[66:67], v23 offset:512
    ds_read_b64_tr_b16 v[68:69], v24 offset:0
    ds_read_b64_tr_b16 v[70:71], v24 offset:512
    ds_read_b128 v[168:171], v16 offset:0
    ds_read_b128 v[172:175], v16 offset:2048
    ds_read_b64_tr_b16 v[72:73], v25 offset:0
    ds_read_b64_tr_b16 v[74:75], v25 offset:512
    s_add_u32 m0, s100, 65536
    s_mov_b32 s80, 458752
    s_movk_i32 s76, 256
    s_waitcnt lgkmcnt(8)
    v_mfma_f32_16x16x32_bf16 v[88:91], v[56:59], v[152:155], 0
    buffer_load_dwordx4 v17, s[56:59], s80 offen offset:0 lds
    v_mfma_f32_16x16x32_bf16 v[92:95], v[56:59], v[156:159], 0
    buffer_load_dwordx4 v18, s[56:59], s80 offen offset:1024 lds
    v_mfma_f32_16x16x32_bf16 v[96:99], v[56:59], v[160:163], 0
    v_mfma_f32_16x16x32_bf16 v[100:103], v[56:59], v[164:167], 0
    s_waitcnt vmcnt(11)
    ds_read_b64_tr_b16 v[208:209], v246 offset:512
    v_and_b32 v227, 0xffff0000, v248
    v_mfma_f32_16x16x32_bf16 a[252:255], v[56:59], a[224:227], 0
    ds_read_b64_tr_b16 v[210:211], v246 offset:1024
    ds_read_b64_tr_b16 v[212:213], v246 offset:1536
    ds_read_b64_tr_b16 v[214:215], v246 offset:2048
    ds_read_b64_tr_b16 v[216:217], v246 offset:2560
    ds_read_b64_tr_b16 v[224:225], v246 offset:3072
    ds_read_b64_tr_b16 v[222:223], v246 offset:3584
    v_mfma_f32_16x16x32_bf16 v[104:107], v[60:63], v[152:155], 0
    ds_read_b64_tr_b16 v[220:221], v246 offset:4096
    v_lshlrev_b32 v228, 16, v249
    v_mfma_f32_16x16x32_bf16 v[108:111], v[60:63], v[156:159], 0
    ds_read_b64_tr_b16 v[218:219], v246 offset:4608
    v_and_b32 v229, 0xffff0000, v249
    v_mfma_f32_16x16x32_bf16 v[112:115], v[60:63], v[160:163], 0
    ds_read_b128 v[176:179], v16 offset:4096
    v_mfma_f32_16x16x32_bf16 v[116:119], v[60:63], v[164:167], 0
    ds_read_b128 v[180:183], v16 offset:6144
    v_mfma_f32_16x16x32_bf16 a[252:255], v[60:63], a[228:231], a[252:255]
    ds_read_b64_tr_b16 v[76:77], v26 offset:0
    s_waitcnt lgkmcnt(15)
    v_mfma_f32_16x16x32_bf16 v[120:123], v[64:67], v[152:155], 0
    ds_read_b64_tr_b16 v[78:79], v26 offset:512
    s_waitcnt lgkmcnt(12)
    v_and_b32 v240, 0xffff0000, v208
    v_mfma_f32_16x16x32_bf16 v[124:127], v[64:67], v[156:159], 0
    buffer_load_dwordx4 v19, s[56:59], s80 offen offset:2048 lds
    v_mfma_f32_16x16x32_bf16 v[128:131], v[64:67], v[160:163], 0
    ds_read_b64_tr_b16 v[80:81], v27 offset:0
    v_lshlrev_b32 v241, 16, v209
    v_mfma_f32_16x16x32_bf16 v[132:135], v[64:67], v[164:167], 0
    ds_read_b64_tr_b16 v[82:83], v27 offset:512
    s_waitcnt lgkmcnt(8)
    v_swap_b32 v222, v223
    v_mfma_f32_16x16x32_bf16 a[252:255], v[64:67], a[232:235], a[252:255]
    buffer_load_dwordx4 v20, s[56:59], s80 offen offset:3072 lds
    v_mfma_f32_16x16x32_bf16 v[136:139], v[68:71], v[152:155], 0
    ds_read_b64_tr_b16 v[84:85], v28 offset:0
    s_waitcnt lgkmcnt(7)
    v_lshlrev_b32 v226, 16, v248
    v_mfma_f32_16x16x32_bf16 v[140:143], v[68:71], v[156:159], 0
    ds_read_b64_tr_b16 v[86:87], v28 offset:512
    v_swap_b32 v218, v219
    v_mfma_f32_16x16x32_bf16 v[144:147], v[68:71], v[160:163], 0
    v_swap_b32 v220, v221
    v_swap_b32 v224, v225
    v_mfma_f32_16x16x32_bf16 v[148:151], v[68:71], v[164:167], 0
    v_and_b32 v242, 0xffff0000, v209
    v_lshlrev_b32 v244, 16, v210
    v_mfma_f32_16x16x32_bf16 a[252:255], v[68:71], a[236:239], a[252:255]
    v_and_b32 v245, 0xffff0000, v210
    v_mul_f32 v230, v240, v229
    v_mul_f32 v231, v241, v229
    v_fmac_f32 v230, v241, v228
    v_fmac_f32 v231, v242, v228
    v_fmac_f32 v230, v242, v227
    s_add_u32 m0, s100, 81920
    v_fmac_f32 v231, v244, v227
    buffer_load_dwordx4 v11, s[44:47], s76 offen offset:0 lds
    buffer_load_dwordx4 v12, s[44:47], s76 offen offset:1024 lds
    s_waitcnt lgkmcnt(4)
    v_mfma_f32_16x16x32_bf16 v[88:91], v[72:75], v[168:171], v[88:91]
    buffer_load_dwordx4 v13, s[44:47], s76 offen offset:2048 lds
    v_mfma_f32_16x16x32_bf16 v[92:95], v[72:75], v[172:175], v[92:95]
    v_fmac_f32 v230, v244, v226
    v_fmac_f32 v231, v245, v226
    v_mfma_f32_16x16x32_bf16 v[96:99], v[72:75], v[176:179], v[96:99]
    v_lshlrev_b32 v232, 16, v225
    v_and_b32 v233, 0xffff0000, v225
    v_mfma_f32_16x16x32_bf16 v[100:103], v[72:75], v[180:183], v[100:103]
    v_mul_f32 v230, v230, v232
    v_mul_f32 v231, v231, v233
    s_waitcnt vmcnt(8) lgkmcnt(0)
    s_barrier
    ds_read_b128 v[152:155], v15 offset:32768
    ds_read_b128 v[156:159], v15 offset:34816
    v_mfma_f32_16x16x32_bf16 v[104:107], v[76:79], v[168:171], v[104:107]
    buffer_load_dwordx4 v14, s[44:47], s76 offen offset:3072 lds
    v_mfma_f32_16x16x32_bf16 v[108:111], v[76:79], v[172:175], v[108:111]
    ds_read_b64_tr_b16 v[56:57], v21 offset:32768
    s_add_u32 m0, s100, 98304
    v_mfma_f32_16x16x32_bf16 v[112:115], v[76:79], v[176:179], v[112:115]
    ds_read_b64_tr_b16 v[58:59], v21 offset:33280
    s_mov_b32 s80, 688128
    v_mfma_f32_16x16x32_bf16 v[116:119], v[76:79], v[180:183], v[116:119]
    buffer_load_dwordx4 v17, s[56:59], s80 offen offset:0 lds
    v_mfma_f32_16x16x32_bf16 v[120:123], v[80:83], v[168:171], v[120:123]
    ds_read_b128 v[160:163], v15 offset:36864
    v_cvt_pk_bf16_f32 v225, v231, v230
    v_mfma_f32_16x16x32_bf16 v[124:127], v[80:83], v[172:175], v[124:127]
    ds_read_b128 v[164:167], v15 offset:38912
    v_lshlrev_b32 v240, 16, v211
    v_mfma_f32_16x16x32_bf16 v[128:131], v[80:83], v[176:179], v[128:131]
    ds_read_b64_tr_b16 v[60:61], v22 offset:32768
    v_and_b32 v241, 0xffff0000, v211
    v_mfma_f32_16x16x32_bf16 v[132:135], v[80:83], v[180:183], v[132:135]
    ds_read_b64_tr_b16 v[62:63], v22 offset:33280
    buffer_load_dwordx4 v18, s[56:59], s80 offen offset:1024 lds
    v_mfma_f32_16x16x32_bf16 v[136:139], v[84:87], v[168:171], v[136:139]
    ds_read_b64_tr_b16 v[64:65], v23 offset:32768
    v_mul_f32 v230, v242, v229
    v_mfma_f32_16x16x32_bf16 v[140:143], v[84:87], v[172:175], v[140:143]
    ds_read_b64_tr_b16 v[66:67], v23 offset:33280
    v_mul_f32 v231, v244, v229
    v_mfma_f32_16x16x32_bf16 v[144:147], v[84:87], v[176:179], v[144:147]
    v_fmac_f32 v230, v244, v228
    v_fmac_f32 v231, v245, v228
    v_fmac_f32 v230, v245, v227
    v_fmac_f32 v231, v240, v227
    v_fmac_f32 v230, v240, v226
    v_fmac_f32 v231, v241, v226
    v_lshlrev_b32 v232, 16, v224
    buffer_load_dwordx4 v19, s[56:59], s80 offen offset:2048 lds
    v_mfma_f32_16x16x32_bf16 v[148:151], v[84:87], v[180:183], v[148:151]
    buffer_load_dwordx4 v20, s[56:59], s80 offen offset:3072 lds
    ds_read_b64_tr_b16 v[68:69], v24 offset:32768
    ds_read_b64_tr_b16 v[70:71], v24 offset:33280
    v_and_b32 v233, 0xffff0000, v224
    v_mul_f32 v230, v230, v232
    v_mul_f32 v231, v231, v233
    v_cvt_pk_bf16_f32 v224, v231, v230
    s_waitcnt lgkmcnt(4)
    v_mfma_f32_16x16x32_bf16 v[88:91], v[56:59], v[152:155], v[88:91]
    ds_read_b128 v[168:171], v16 offset:32768
    v_lshlrev_b32 v242, 16, v212
    v_mfma_f32_16x16x32_bf16 v[92:95], v[56:59], v[156:159], v[92:95]
    ds_read_b128 v[172:175], v16 offset:34816
    v_and_b32 v244, 0xffff0000, v212
    v_mfma_f32_16x16x32_bf16 v[96:99], v[56:59], v[160:163], v[96:99]
    ds_read_b64_tr_b16 v[72:73], v25 offset:32768
    s_add_u32 m0, s100, 114688
    v_mfma_f32_16x16x32_bf16 v[100:103], v[56:59], v[164:167], v[100:103]
    ds_read_b64_tr_b16 v[74:75], v25 offset:33280
    s_movk_i32 s76, 384
    v_mfma_f32_16x16x32_bf16 a[252:255], v[56:59], a[224:227], a[252:255]
    buffer_load_dwordx4 v11, s[44:47], s76 offen offset:0 lds
    v_mfma_f32_16x16x32_bf16 v[104:107], v[60:63], v[152:155], v[104:107]
    buffer_load_dwordx4 v12, s[44:47], s76 offen offset:1024 lds
    v_mfma_f32_16x16x32_bf16 v[108:111], v[60:63], v[156:159], v[108:111]
    buffer_load_dwordx4 v13, s[44:47], s76 offen offset:2048 lds
    v_mfma_f32_16x16x32_bf16 v[112:115], v[60:63], v[160:163], v[112:115]
    ds_read_b128 v[176:179], v16 offset:36864
    v_mul_f32 v230, v245, v229
    v_mfma_f32_16x16x32_bf16 v[116:119], v[60:63], v[164:167], v[116:119]
    ds_read_b128 v[180:183], v16 offset:38912
    v_mul_f32 v231, v240, v229
    v_mfma_f32_16x16x32_bf16 a[252:255], v[60:63], a[228:231], a[252:255]
    ds_read_b64_tr_b16 v[76:77], v26 offset:32768
    v_fmac_f32 v230, v240, v228
    s_waitcnt lgkmcnt(7)
    v_mfma_f32_16x16x32_bf16 v[120:123], v[64:67], v[152:155], v[120:123]
    ds_read_b64_tr_b16 v[78:79], v26 offset:33280
    v_fmac_f32 v231, v241, v228
    v_mfma_f32_16x16x32_bf16 v[124:127], v[64:67], v[156:159], v[124:127]
    buffer_load_dwordx4 v14, s[44:47], s76 offen offset:3072 lds
    v_mfma_f32_16x16x32_bf16 v[128:131], v[64:67], v[160:163], v[128:131]
    ds_read_b64_tr_b16 v[80:81], v27 offset:32768
    v_fmac_f32 v230, v241, v227
    v_mfma_f32_16x16x32_bf16 v[132:135], v[64:67], v[164:167], v[132:135]
    buffer_load_dword a223, v7, s[60:63], 0 offen
    v_mfma_f32_16x16x32_bf16 a[252:255], v[64:67], a[232:235], a[252:255]
    ds_read_b64_tr_b16 v[82:83], v27 offset:33280
    v_fmac_f32 v231, v242, v227
    v_mfma_f32_16x16x32_bf16 v[136:139], v[68:71], v[152:155], v[136:139]
    ds_read_b64_tr_b16 v[84:85], v28 offset:32768
    v_fmac_f32 v230, v242, v226
    v_mfma_f32_16x16x32_bf16 v[140:143], v[68:71], v[156:159], v[140:143]
    ds_read_b64_tr_b16 v[86:87], v28 offset:33280
    v_fmac_f32 v231, v244, v226
    v_mfma_f32_16x16x32_bf16 v[144:147], v[68:71], v[160:163], v[144:147]
    v_lshlrev_b32 v232, 16, v223
    v_and_b32 v233, 0xffff0000, v223
    v_mfma_f32_16x16x32_bf16 v[148:151], v[68:71], v[164:167], v[148:151]
    v_mul_f32 v230, v230, v232
    v_mul_f32 v231, v231, v233
    v_mfma_f32_16x16x32_bf16 a[252:255], v[68:71], a[236:239], a[252:255]
    v_cvt_pk_bf16_f32 v223, v231, v230
    v_lshlrev_b32 v245, 16, v213
    v_and_b32 v240, 0xffff0000, v213
    v_mul_f32 v230, v241, v229
    v_mul_f32 v231, v242, v229
    v_fmac_f32 v230, v242, v228
    v_fmac_f32 v231, v244, v228
    v_fmac_f32 v230, v244, v227
    v_fmac_f32 v231, v245, v227
    v_fmac_f32 v230, v245, v226
    v_fmac_f32 v231, v240, v226
    v_lshlrev_b32 v232, 16, v222
    v_and_b32 v233, 0xffff0000, v222
    v_mul_f32 v230, v230, v232
    v_mul_f32 v231, v231, v233
    s_add_u32 m0, s100, 0
    s_mov_b32 s80, 917504
    buffer_load_dwordx4 v17, s[56:59], s80 offen offset:0 lds
    buffer_load_dwordx4 v18, s[56:59], s80 offen offset:1024 lds
    buffer_load_dwordx4 v19, s[56:59], s80 offen offset:2048 lds
    buffer_load_dwordx4 v20, s[56:59], s80 offen offset:3072 lds
    s_waitcnt lgkmcnt(4)
    v_mfma_f32_16x16x32_bf16 v[88:91], v[72:75], v[168:171], v[88:91]
    v_cvt_pk_bf16_f32 v222, v231, v230
    v_lshlrev_b32 v241, 16, v214
    v_and_b32 v242, 0xffff0000, v214
    v_mul_f32 v230, v244, v229
    v_mul_f32 v231, v245, v229
    v_fmac_f32 v230, v245, v228
    v_fmac_f32 v231, v240, v228
    s_add_u32 m0, s100, 16384
    s_movk_i32 s76, 512
    buffer_load_dwordx4 v11, s[44:47], s76 offen offset:0 lds
    v_mfma_f32_16x16x32_bf16 v[92:95], v[72:75], v[172:175], v[92:95]
    s_waitcnt vmcnt(14) lgkmcnt(0)
    s_barrier
    v_add_u32 v15, 65536, v15
    v_mfma_f32_16x16x32_bf16 v[96:99], v[72:75], v[176:179], v[96:99]
    buffer_load_dwordx4 v12, s[44:47], s76 offen offset:1024 lds
    v_mfma_f32_16x16x32_bf16 v[100:103], v[72:75], v[180:183], v[100:103]
    ds_read_b128 v[152:155], v15 offset:0
    ds_read_b128 v[156:159], v15 offset:2048
    v_mfma_f32_16x16x32_bf16 v[104:107], v[76:79], v[168:171], v[104:107]
    buffer_load_dwordx4 v13, s[44:47], s76 offen offset:2048 lds
    v_mfma_f32_16x16x32_bf16 v[108:111], v[76:79], v[172:175], v[108:111]
    buffer_load_dwordx4 v14, s[44:47], s76 offen offset:3072 lds
    v_mfma_f32_16x16x32_bf16 v[112:115], v[76:79], v[176:179], v[112:115]
    v_add_u32 v21, 65536, v21
    v_add_u32 v22, 65536, v22
    v_mfma_f32_16x16x32_bf16 v[116:119], v[76:79], v[180:183], v[116:119]
    ds_read_b64_tr_b16 v[56:57], v21 offset:0
    ds_read_b64_tr_b16 v[58:59], v21 offset:512
    v_mfma_f32_16x16x32_bf16 v[120:123], v[80:83], v[168:171], v[120:123]
    ds_read_b128 v[160:163], v15 offset:4096
    v_add_u32 v23, 65536, v23
    v_mfma_f32_16x16x32_bf16 v[124:127], v[80:83], v[172:175], v[124:127]
    ds_read_b128 v[164:167], v15 offset:6144
    v_add_u32 v24, 65536, v24
    v_mfma_f32_16x16x32_bf16 v[128:131], v[80:83], v[176:179], v[128:131]
    ds_read_b64_tr_b16 v[60:61], v22 offset:0
    v_add_u32 v16, 65536, v16
    v_mfma_f32_16x16x32_bf16 v[132:135], v[80:83], v[180:183], v[132:135]
    ds_read_b64_tr_b16 v[62:63], v22 offset:512
    v_add_u32 v25, 65536, v25
    v_mfma_f32_16x16x32_bf16 v[136:139], v[84:87], v[168:171], v[136:139]
    ds_read_b64_tr_b16 v[64:65], v23 offset:0
    v_add_u32 v26, 65536, v26
    v_mfma_f32_16x16x32_bf16 v[140:143], v[84:87], v[172:175], v[140:143]
    ds_read_b64_tr_b16 v[66:67], v23 offset:512
    v_add_u32 v27, 65536, v27
    v_mfma_f32_16x16x32_bf16 v[144:147], v[84:87], v[176:179], v[144:147]
    ds_read_b64_tr_b16 v[68:69], v24 offset:0
    v_add_u32 v28, 65536, v28
    v_mfma_f32_16x16x32_bf16 v[148:151], v[84:87], v[180:183], v[148:151]
    v_fmac_f32 v230, v240, v227
    v_fmac_f32 v231, v241, v227
    v_fmac_f32 v230, v241, v226
    v_fmac_f32 v231, v242, v226
    v_lshlrev_b32 v232, 16, v221
    v_and_b32 v233, 0xffff0000, v221
    v_mul_f32 v230, v230, v232
    v_mul_f32 v231, v231, v233
    v_cvt_pk_bf16_f32 v221, v231, v230
    v_lshlrev_b32 v244, 16, v215
    v_and_b32 v245, 0xffff0000, v215
    v_mul_f32 v230, v240, v229
    v_mul_f32 v231, v241, v229
    v_fmac_f32 v230, v241, v228
    v_fmac_f32 v231, v242, v228
    v_fmac_f32 v230, v242, v227
    v_fmac_f32 v231, v244, v227
    v_fmac_f32 v230, v244, v226
    s_waitcnt lgkmcnt(3)
    v_mfma_f32_16x16x32_bf16 v[88:91], v[56:59], v[152:155], v[88:91]
    ds_read_b64_tr_b16 v[70:71], v24 offset:512
    v_cmp_eq_u64 vcc, 0, v[4:5]
    v_mfma_f32_16x16x32_bf16 v[92:95], v[56:59], v[156:159], v[92:95]
    ds_read_b128 v[168:171], v16 offset:0
    s_add_u32 m0, s100, 32768
    v_mfma_f32_16x16x32_bf16 v[96:99], v[56:59], v[160:163], v[96:99]
    ds_read_b128 v[172:175], v16 offset:2048
    s_cbranch_vccnz Lslow_nonce
Lback_nonce:
    v_mfma_f32_16x16x32_bf16 v[100:103], v[56:59], v[164:167], v[100:103]
    ds_read_b64_tr_b16 v[72:73], v25 offset:0
    v_readfirstlane_b32 s6, v4
    v_mfma_f32_16x16x32_bf16 a[252:255], v[56:59], a[224:227], a[252:255]
    ds_read_b64_tr_b16 v[74:75], v25 offset:512
    v_readfirstlane_b32 s7, v5
    s_mov_b32 s72, s38
    s_and_b32 s73, s39, 0xffff
    s_mov_b32 s74, 2097152
    s_mov_b32 s75, 0x20000
    v_mov_b32 v238, v4
    v_mov_b32 v239, v5
    buffer_store_dwordx4 v[236:239], v49, s[68:71], s21 offen sc1
    v_mfma_f32_16x16x32_bf16 v[104:107], v[60:63], v[152:155], v[104:107]
    s_mov_b32 s80, 1146880
    buffer_load_dwordx4 v17, s[56:59], s80 offen offset:0 lds
    v_mfma_f32_16x16x32_bf16 v[108:111], v[60:63], v[156:159], v[108:111]
    buffer_load_dwordx4 v18, s[56:59], s80 offen offset:1024 lds
    v_mfma_f32_16x16x32_bf16 v[112:115], v[60:63], v[160:163], v[112:115]
    ds_read_b128 v[176:179], v16 offset:4096
    v_fmac_f32 v231, v245, v226
    v_mfma_f32_16x16x32_bf16 v[116:119], v[60:63], v[164:167], v[116:119]
    ds_read_b128 v[180:183], v16 offset:6144
    v_lshlrev_b32 v232, 16, v220
    v_mfma_f32_16x16x32_bf16 a[252:255], v[60:63], a[228:231], a[252:255]
    ds_read_b64_tr_b16 v[76:77], v26 offset:0
    v_and_b32 v233, 0xffff0000, v220
    s_waitcnt lgkmcnt(7)
    v_mfma_f32_16x16x32_bf16 v[120:123], v[64:67], v[152:155], v[120:123]
    ds_read_b64_tr_b16 v[78:79], v26 offset:512
    v_mul_f32 v230, v230, v232
    v_mfma_f32_16x16x32_bf16 v[124:127], v[64:67], v[156:159], v[124:127]
    buffer_load_dwordx4 v19, s[56:59], s80 offen offset:2048 lds
    v_mfma_f32_16x16x32_bf16 v[128:131], v[64:67], v[160:163], v[128:131]
    buffer_load_dwordx4 v20, s[56:59], s80 offen offset:3072 lds
    v_mfma_f32_16x16x32_bf16 v[132:135], v[64:67], v[164:167], v[132:135]
    ds_read_b64_tr_b16 v[80:81], v27 offset:0
    v_mul_f32 v231, v231, v233
    v_mfma_f32_16x16x32_bf16 a[252:255], v[64:67], a[232:235], a[252:255]
    ds_read_b64_tr_b16 v[82:83], v27 offset:512
    v_cvt_pk_bf16_f32 v220, v231, v230
    v_mfma_f32_16x16x32_bf16 v[136:139], v[68:71], v[152:155], v[136:139]
    ds_read_b64_tr_b16 v[84:85], v28 offset:0
    v_lshlrev_b32 v240, 16, v216
    v_mfma_f32_16x16x32_bf16 v[140:143], v[68:71], v[156:159], v[140:143]
    v_and_b32 v241, 0xffff0000, v216
    v_mul_f32 v230, v242, v229
    v_mul_f32 v231, v244, v229
    v_fmac_f32 v230, v244, v228
    v_fmac_f32 v231, v245, v228
    v_fmac_f32 v230, v245, v227
    v_fmac_f32 v231, v240, v227
    v_fmac_f32 v230, v240, v226
    v_fmac_f32 v231, v241, v226
    v_lshlrev_b32 v232, 16, v219
    v_and_b32 v233, 0xffff0000, v219
    v_mul_f32 v230, v230, v232
    s_add_u32 m0, s100, 49152
    s_movk_i32 s76, 640
    buffer_load_dwordx4 v11, s[44:47], s76 offen offset:0 lds
    v_mfma_f32_16x16x32_bf16 v[144:147], v[68:71], v[160:163], v[144:147]
    buffer_load_dwordx4 v12, s[44:47], s76 offen offset:1024 lds
    v_mfma_f32_16x16x32_bf16 v[148:151], v[68:71], v[164:167], v[148:151]
    ds_read_b64_tr_b16 v[86:87], v28 offset:512
    v_mul_f32 v231, v231, v233
    v_mfma_f32_16x16x32_bf16 a[252:255], v[68:71], a[236:239], a[252:255]
    v_cvt_pk_bf16_f32 v219, v231, v230
    v_lshlrev_b32 v242, 16, v217
    v_and_b32 v244, 0xffff0000, v217
    v_mul_f32 v230, v245, v229
    v_mul_f32 v231, v240, v229
    v_fmac_f32 v230, v240, v228
    v_fmac_f32 v231, v241, v228
    v_fmac_f32 v230, v241, v227
    v_fmac_f32 v231, v242, v227
    buffer_load_dwordx4 v13, s[44:47], s76 offen offset:2048 lds
    s_waitcnt lgkmcnt(4)
    v_mfma_f32_16x16x32_bf16 v[88:91], v[72:75], v[168:171], v[88:91]
    buffer_load_dwordx4 v14, s[44:47], s76 offen offset:3072 lds
    v_mfma_f32_16x16x32_bf16 v[92:95], v[72:75], v[172:175], v[92:95]
    v_fmac_f32 v230, v242, v226
    v_fmac_f32 v231, v244, v226
    v_mfma_f32_16x16x32_bf16 v[96:99], v[72:75], v[176:179], v[96:99]
    v_lshlrev_b32 v232, 16, v218
    v_and_b32 v233, 0xffff0000, v218
    v_mfma_f32_16x16x32_bf16 v[100:103], v[72:75], v[180:183], v[100:103]
    v_mul_f32 v230, v230, v232
    v_mul_f32 v231, v231, v233
    v_cvt_pk_bf16_f32 v218, v231, v230
    v_xor_b32 v230, 16, v44
    ds_write_b128 v44, v[218:221]
    ds_write_b128 v230, v[222:225]
    s_add_u32 m0, s100, 131072
    s_mov_b32 s80, 1605632
    v_lshl_add_u32 v190, v185, 2, v186
    v_bfe_u32 v191, v190, 1, 2
    s_nop 0
    v_lshlrev_b32 v190, 7, v190
    v_lshl_add_u32 v190, v187, 3, v190
    v_lshl_add_u32 v190, v191, 5, v190
    v_add_u32 v34, s100, v190
    v_xor_b32 v35, 32, v34
    s_movk_i32 s76, 768
    s_waitcnt vmcnt(18) lgkmcnt(0)
    s_barrier
    ds_read_b128 v[152:155], v15 offset:32768
    ds_read_b128 v[156:159], v15 offset:34816
    v_mfma_f32_16x16x32_bf16 v[104:107], v[76:79], v[168:171], v[104:107]
    ds_read_b64_tr_b16 v[56:57], v21 offset:32768
    v_xor_b32 v36, 64, v34
    v_mfma_f32_16x16x32_bf16 v[108:111], v[76:79], v[172:175], v[108:111]
    buffer_load_dwordx4 v17, s[56:59], s80 offen offset:0 lds
    v_mfma_f32_16x16x32_bf16 v[112:115], v[76:79], v[176:179], v[112:115]
    ds_read_b64_tr_b16 v[58:59], v21 offset:33280
    v_xor_b32 v37, 96, v34
    v_mfma_f32_16x16x32_bf16 v[116:119], v[76:79], v[180:183], v[116:119]
    buffer_load_dwordx4 v18, s[56:59], s80 offen offset:1024 lds
    v_mfma_f32_16x16x32_bf16 v[120:123], v[80:83], v[168:171], v[120:123]
    ds_read_b128 v[160:163], v15 offset:36864
    v_and_b32 v192, 1, v0
    v_mfma_f32_16x16x32_bf16 v[124:127], v[80:83], v[172:175], v[124:127]
    ds_read_b128 v[164:167], v15 offset:38912
    s_and_b32 s99, s3, 1
    v_mfma_f32_16x16x32_bf16 v[128:131], v[80:83], v[176:179], v[128:131]
    ds_read_b64_tr_b16 v[60:61], v22 offset:32768
    s_lshr_b32 s15, s3, 1
    v_mfma_f32_16x16x32_bf16 v[132:135], v[80:83], v[180:183], v[132:135]
    ds_read_b64_tr_b16 v[62:63], v22 offset:33280
    s_mul_i32 s98, s15, 8320
    v_mfma_f32_16x16x32_bf16 v[136:139], v[84:87], v[168:171], v[136:139]
    buffer_load_dwordx4 v19, s[56:59], s80 offen offset:2048 lds
    v_mfma_f32_16x16x32_bf16 v[140:143], v[84:87], v[172:175], v[140:143]
    ds_read_b64_tr_b16 v[64:65], v23 offset:32768
    s_lshl_b32 s99, s99, 8
    v_mfma_f32_16x16x32_bf16 v[144:147], v[84:87], v[176:179], v[144:147]
    ds_read_b64_tr_b16 v[66:67], v23 offset:33280
    s_add_u32 s90, s98, 122912
    v_mfma_f32_16x16x32_bf16 v[148:151], v[84:87], v[180:183], v[148:151]
    buffer_load_dwordx4 v20, s[56:59], s80 offen offset:3072 lds
    ds_read_b64_tr_b16 v[68:69], v24 offset:32768
    ds_read_b64_tr_b16 v[70:71], v24 offset:33280
    global_load_dwordx2 v[234:235], v50, s[32:33]
    ds_read_b128 v[168:171], v16 offset:32768
    ds_read_b128 v[172:175], v16 offset:34816
    ds_read_b64_tr_b16 v[72:73], v25 offset:32768
    ds_read_b64_tr_b16 v[74:75], v25 offset:33280
    s_add_u32 m0, s100, 65536
    s_mov_b32 s80, 1376256
    buffer_load_dwordx4 v17, s[56:59], s80 offen offset:0 lds
    buffer_load_dwordx4 v18, s[56:59], s80 offen offset:1024 lds
    v_add_u32 v252, s90, v43
    s_waitcnt lgkmcnt(8)
    v_mfma_f32_16x16x32_bf16 v[88:91], v[56:59], v[152:155], v[88:91]
    ds_read_b128 v[208:211], v45
    s_add_u32 s98, s98, s99
    v_mfma_f32_16x16x32_bf16 v[92:95], v[56:59], v[156:159], v[92:95]
    ds_read_b128 v[212:215], v45 offset:1024
    v_add_u32 v15, 4294901760, v15
    v_mfma_f32_16x16x32_bf16 v[96:99], v[56:59], v[160:163], v[96:99]
    ds_read_b128 v[176:179], v16 offset:36864
    v_add_u32 v21, 4294901760, v21
    v_mfma_f32_16x16x32_bf16 v[100:103], v[56:59], v[164:167], v[100:103]
    ds_read_b128 v[180:183], v16 offset:38912
    v_add_u32 v22, 4294901760, v22
    v_mfma_f32_16x16x32_bf16 a[252:255], v[56:59], a[224:227], a[252:255]
    ds_read_b64_tr_b16 v[76:77], v26 offset:32768
    v_add_u32 v23, 4294901760, v23
    v_mfma_f32_16x16x32_bf16 v[104:107], v[60:63], v[152:155], v[104:107]
    ds_read_b64_tr_b16 v[78:79], v26 offset:33280
    v_add_u32 v24, 4294901760, v24
    v_mfma_f32_16x16x32_bf16 v[108:111], v[60:63], v[156:159], v[108:111]
    buffer_load_dwordx4 v19, s[56:59], s80 offen offset:2048 lds
    v_mfma_f32_16x16x32_bf16 v[112:115], v[60:63], v[160:163], v[112:115]
    buffer_load_dwordx4 v20, s[56:59], s80 offen offset:3072 lds
    v_mfma_f32_16x16x32_bf16 v[116:119], v[60:63], v[164:167], v[116:119]
    ds_read_b64_tr_b16 v[80:81], v27 offset:32768
    s_add_u32 m0, s100, 81920
    v_mfma_f32_16x16x32_bf16 a[252:255], v[60:63], a[228:231], a[252:255]
    ds_read_b64_tr_b16 v[82:83], v27 offset:33280
    v_add_u32 v16, 4294901760, v16
    s_waitcnt lgkmcnt(12)
    v_mfma_f32_16x16x32_bf16 v[120:123], v[64:67], v[152:155], v[120:123]
    buffer_load_dwordx4 v11, s[44:47], s76 offen offset:0 lds
    v_mfma_f32_16x16x32_bf16 v[124:127], v[64:67], v[156:159], v[124:127]
    ds_read_b64_tr_b16 v[84:85], v28 offset:32768
    v_add_u32 v25, 4294901760, v25
    v_mfma_f32_16x16x32_bf16 v[128:131], v[64:67], v[160:163], v[128:131]
    ds_read_b64_tr_b16 v[86:87], v28 offset:33280
    v_add_u32 v26, 4294901760, v26
    v_mfma_f32_16x16x32_bf16 v[132:135], v[64:67], v[164:167], v[132:135]
    buffer_load_dwordx4 v12, s[44:47], s76 offen offset:1024 lds
    v_mfma_f32_16x16x32_bf16 a[252:255], v[64:67], a[232:235], a[252:255]
    v_add_u32 v27, 4294901760, v27
    v_add_u32 v28, 4294901760, v28
    v_mfma_f32_16x16x32_bf16 v[136:139], v[68:71], v[152:155], v[136:139]
    s_add_u32 s98, s98, 122884
    v_mul_u32_u24 v190, 4160, v192
    v_mfma_f32_16x16x32_bf16 v[140:143], v[68:71], v[156:159], v[140:143]
    v_lshrrev_b32 v191, 1, v184
    v_lshl_add_u32 v190, v191, 2, v190
    v_mfma_f32_16x16x32_bf16 v[144:147], v[68:71], v[160:163], v[144:147]
    v_lshl_add_u32 v190, v185, 4, v190
    v_add_u32 v38, s98, v190
    v_mfma_f32_16x16x32_bf16 v[148:151], v[68:71], v[164:167], v[148:151]
    v_add_u32 v39, 1024, v38
    v_add_u32 v40, 2048, v38
    v_mfma_f32_16x16x32_bf16 a[252:255], v[68:71], a[236:239], a[252:255]
    v_add_u32 v41, 3072, v38
    s_mul_i32 s15, s15, 4608
    s_waitcnt lgkmcnt(4)
    v_mfma_f32_16x16x32_bf16 v[88:91], v[72:75], v[168:171], v[88:91]
    s_add_u32 s15, s15, 139520
    s_add_u32 s98, s15, s99
    v_mfma_f32_16x16x32_bf16 v[92:95], v[72:75], v[172:175], v[92:95]
    s_waitcnt vmcnt(20) lgkmcnt(0)
    s_barrier
    s_add_u32 s98, s98, 480
    v_mfma_f32_16x16x32_bf16 v[96:99], v[72:75], v[176:179], v[96:99]
    buffer_load_dwordx4 v13, s[44:47], s76 offen offset:2048 lds
    v_mfma_f32_16x16x32_bf16 v[100:103], v[72:75], v[180:183], v[100:103]
    ds_read_b128 v[152:155], v15 offset:0
    ds_read_b128 v[156:159], v15 offset:2048
    v_mfma_f32_16x16x32_bf16 v[104:107], v[76:79], v[168:171], v[104:107]
    ds_read_b64_tr_b16 v[56:57], v21 offset:0
    v_lshlrev_b32 v190, 4, v185
    v_mfma_f32_16x16x32_bf16 v[108:111], v[76:79], v[172:175], v[108:111]
    ds_read_b64_tr_b16 v[58:59], v21 offset:512
    v_lshlrev_b32 v191, 5, v184
    v_mfma_f32_16x16x32_bf16 v[112:115], v[76:79], v[176:179], v[112:115]
    buffer_load_dwordx4 v14, s[44:47], s76 offen offset:3072 lds
    v_mfma_f32_16x16x32_bf16 v[116:119], v[76:79], v[180:183], v[116:119]
    buffer_store_dwordx4 v[208:211], v46, s[68:71], s20 offen sc1
    v_mfma_f32_16x16x32_bf16 v[120:123], v[80:83], v[168:171], v[120:123]
    ds_read_b128 v[160:163], v15 offset:4096
    s_add_u32 s20, s20, 0x8000
    v_mfma_f32_16x16x32_bf16 v[124:127], v[80:83], v[172:175], v[124:127]
    ds_read_b128 v[164:167], v15 offset:6144
    v_sub_u32 v190, v190, v191
    v_mfma_f32_16x16x32_bf16 v[128:131], v[80:83], v[176:179], v[128:131]
    ds_read_b64_tr_b16 v[60:61], v22 offset:0
    v_add_u32 v42, s98, v190
    v_mfma_f32_16x16x32_bf16 v[132:135], v[80:83], v[180:183], v[132:135]
    ds_read_b64_tr_b16 v[62:63], v22 offset:512
    v_add_u32 v253, s15, v2
    v_mfma_f32_16x16x32_bf16 v[136:139], v[84:87], v[168:171], v[136:139]
    ds_read_b64_tr_b16 v[64:65], v23 offset:0
    v_add_u32 v51, s15, v43
    v_mfma_f32_16x16x32_bf16 v[140:143], v[84:87], v[172:175], v[140:143]
    ds_read_b64_tr_b16 v[66:67], v23 offset:512
    s_mul_i32 s15, s3, 4160
    v_mfma_f32_16x16x32_bf16 v[144:147], v[84:87], v[176:179], v[144:147]
    ds_read_b64_tr_b16 v[68:69], v24 offset:0
    s_add_u32 s15, s15, 122880
    v_mfma_f32_16x16x32_bf16 v[148:151], v[84:87], v[180:183], v[148:151]
    ds_read_b64_tr_b16 v[70:71], v24 offset:512
    ds_read_b128 v[168:171], v16 offset:0
    ds_read_b128 v[172:175], v16 offset:2048
    ds_read_b64_tr_b16 v[72:73], v25 offset:0
    ds_read_b64_tr_b16 v[74:75], v25 offset:512
    buffer_store_dwordx4 v[212:215], v46, s[68:71], s20 offen sc1
    s_add_u32 s20, s20, 0x8000
    v_and_b32 v190, 24, v2
    v_add_u32 v254, s15, v190
    s_lshl_b32 s15, s8, 14
    s_lshr_b32 s98, s9, 3
    s_lshl_b32 s98, s98, 7
    s_add_u32 s15, s15, s98
    s_andn2_b32 s98, 1, s3
    s_lshl_b32 s98, s98, 13
    s_add_u32 s15, s15, s98
    s_waitcnt lgkmcnt(8)
    v_mfma_f32_16x16x32_bf16 v[88:91], v[56:59], v[152:155], v[88:91]
    ds_read_b128 v[176:179], v16 offset:4096
    v_lshrrev_b32 v190, 2, v0
    v_mfma_f32_16x16x32_bf16 v[92:95], v[56:59], v[156:159], v[92:95]
    ds_read_b128 v[180:183], v16 offset:6144
    v_lshl_add_u32 v8, v190, 9, s15
    v_mfma_f32_16x16x32_bf16 v[96:99], v[56:59], v[160:163], v[96:99]
    ds_read_b64_tr_b16 v[76:77], v26 offset:0
    s_and_b32 s15, s3, 1
    v_mfma_f32_16x16x32_bf16 v[100:103], v[56:59], v[164:167], v[100:103]
    ds_read_b64_tr_b16 v[78:79], v26 offset:512
    s_lshl1_add_u32 s15, s12, s15
    v_mfma_f32_16x16x32_bf16 a[252:255], v[56:59], a[224:227], a[252:255]
    s_lshl_b32 s87, s15, 10
    s_add_u32 s87, s87, 393216
    v_mfma_f32_16x16x32_bf16 v[104:107], v[60:63], v[152:155], v[104:107]
    ds_read_b64_tr_b16 v[80:81], v27 offset:0
    s_mul_i32 s98, s15, 28
    v_mfma_f32_16x16x32_bf16 v[108:111], v[60:63], v[156:159], v[108:111]
    ds_read_b64_tr_b16 v[82:83], v27 offset:512
    s_add_u32 s98, s98, s84
    v_mfma_f32_16x16x32_bf16 v[112:115], v[60:63], v[160:163], v[112:115]
    s_lshl_b32 s30, s98, 7
    s_add_u32 s30, s30, 131072
    v_mfma_f32_16x16x32_bf16 v[116:119], v[60:63], v[164:167], v[116:119]
    buffer_load_dwordx4 v[224:227], v43, s[64:67], 0 offen
    v_mfma_f32_16x16x32_bf16 a[252:255], v[60:63], a[228:231], a[252:255]
    s_add_u32 m0, s100, 147456
    s_movk_i32 s76, 896
    s_waitcnt lgkmcnt(10)
    v_mfma_f32_16x16x32_bf16 v[120:123], v[64:67], v[152:155], v[120:123]
    ds_read_b64_tr_b16 v[84:85], v28 offset:0
    s_add_u32 s30, s30, s77
    v_mfma_f32_16x16x32_bf16 v[124:127], v[64:67], v[156:159], v[124:127]
    ds_read_b64_tr_b16 v[86:87], v28 offset:512
    s_mul_i32 s15, s15, 229376
    v_mfma_f32_16x16x32_bf16 v[128:131], v[64:67], v[160:163], v[128:131]
    s_lshl_b32 s98, s84, 11
    s_add_u32 s15, s15, s98
    v_mfma_f32_16x16x32_bf16 v[132:135], v[64:67], v[164:167], v[132:135]
    s_add_u32 s15, s15, s77
    s_add_u32 s16, s15, 5242880
    v_mfma_f32_16x16x32_bf16 a[252:255], v[64:67], a[232:235], a[252:255]
    buffer_load_dwordx4 v[228:231], v43, s[64:67], 0 offen offset:1024
    v_mfma_f32_16x16x32_bf16 v[136:139], v[68:71], v[152:155], v[136:139]
    s_add_u32 s17, s15, 5300224
    s_add_u32 s18, s15, 5357568
    v_mfma_f32_16x16x32_bf16 v[140:143], v[68:71], v[156:159], v[140:143]
    s_add_u32 s19, s15, 5414912
    s_mov_b32 s82, 0xc0135761
    v_mfma_f32_16x16x32_bf16 v[144:147], v[68:71], v[160:163], v[144:147]
    s_mov_b32 s83, 0xbdd2d3e8
    s_lshl1_add_u32 s99, s10, s101
    v_mfma_f32_16x16x32_bf16 v[148:151], v[68:71], v[164:167], v[148:151]
    s_lshl2_add_u32 s29, s99, s3
    s_add_u32 s15, s3, 1
    v_mfma_f32_16x16x32_bf16 a[252:255], v[68:71], a[236:239], a[252:255]
    s_and_b32 s15, s15, 3
    s_andn2_b32 s98, s29, 3
    s_waitcnt lgkmcnt(4)
    v_mfma_f32_16x16x32_bf16 v[88:91], v[72:75], v[168:171], v[88:91]
    s_waitcnt vmcnt(17) lgkmcnt(0)
    s_barrier
    s_add_u32 s15, s98, s15
    v_mfma_f32_16x16x32_bf16 v[92:95], v[72:75], v[172:175], v[92:95]
    ds_read_b128 v[152:155], v15 offset:32768
    s_mov_b32 s85, 0
    v_mfma_f32_16x16x32_bf16 v[96:99], v[72:75], v[176:179], v[96:99]
    ds_read_b128 v[156:159], v15 offset:34816
    s_lshl2_add_u32 s15, s15, s3
    v_mfma_f32_16x16x32_bf16 v[100:103], v[72:75], v[180:183], v[100:103]
    ds_read_b64_tr_b16 v[56:57], v21 offset:32768
    s_mul_i32 s48, s15, 14336
    v_mfma_f32_16x16x32_bf16 v[104:107], v[76:79], v[168:171], v[104:107]
    ds_read_b64_tr_b16 v[58:59], v21 offset:33280
    s_add_u32 s48, s48, 5242880
    v_mfma_f32_16x16x32_bf16 v[108:111], v[76:79], v[172:175], v[108:111]
    buffer_load_dword v232, v250, s[64:67], 0 offen
    v_mfma_f32_16x16x32_bf16 v[112:115], v[76:79], v[176:179], v[112:115]
    buffer_load_dword v233, v251, s[64:67], 0 offen
    v_mfma_f32_16x16x32_bf16 v[116:119], v[76:79], v[180:183], v[116:119]
    ds_read_b128 v[160:163], v15 offset:36864
    s_add_u32 s15, s3, 2
    v_mfma_f32_16x16x32_bf16 v[120:123], v[80:83], v[168:171], v[120:123]
    ds_read_b128 v[164:167], v15 offset:38912
    s_and_b32 s15, s15, 3
    v_mfma_f32_16x16x32_bf16 v[124:127], v[80:83], v[172:175], v[124:127]
    ds_read_b64_tr_b16 v[60:61], v22 offset:32768
    s_andn2_b32 s98, s29, 3
    v_mfma_f32_16x16x32_bf16 v[128:131], v[80:83], v[176:179], v[128:131]
    ds_read_b64_tr_b16 v[62:63], v22 offset:33280
    s_add_u32 s15, s98, s15
    v_mfma_f32_16x16x32_bf16 v[132:135], v[80:83], v[180:183], v[132:135]
    buffer_load_dwordx4 v11, s[44:47], s76 offen offset:0 lds
    v_mfma_f32_16x16x32_bf16 v[136:139], v[84:87], v[168:171], v[136:139]
    ds_read_b64_tr_b16 v[64:65], v23 offset:32768
    s_lshl2_add_u32 s15, s15, s3
    v_mfma_f32_16x16x32_bf16 v[140:143], v[84:87], v[172:175], v[140:143]
    ds_read_b64_tr_b16 v[66:67], v23 offset:33280
    s_mul_i32 s49, s15, 14336
    v_mfma_f32_16x16x32_bf16 v[144:147], v[84:87], v[176:179], v[144:147]
    buffer_load_dwordx4 v12, s[44:47], s76 offen offset:1024 lds
    v_mfma_f32_16x16x32_bf16 v[148:151], v[84:87], v[180:183], v[148:151]
    ds_read_b64_tr_b16 v[68:69], v24 offset:32768
    ds_read_b64_tr_b16 v[70:71], v24 offset:33280
    buffer_load_dwordx4 v13, s[44:47], s76 offen offset:2048 lds
    ds_read_b128 v[168:171], v16 offset:32768
    ds_read_b128 v[172:175], v16 offset:34816
    ds_read_b64_tr_b16 v[72:73], v25 offset:32768
    ds_read_b64_tr_b16 v[74:75], v25 offset:33280
    buffer_load_dwordx4 v14, s[44:47], s76 offen offset:3072 lds
    s_add_u32 m0, s100, 98304
    s_add_u32 s49, s49, 5242880
    s_add_u32 s15, s3, 3
    s_waitcnt lgkmcnt(8)
    v_mfma_f32_16x16x32_bf16 v[88:91], v[56:59], v[152:155], v[88:91]
    ds_read_b128 v[176:179], v16 offset:36864
    s_and_b32 s15, s15, 3
    v_mfma_f32_16x16x32_bf16 v[92:95], v[56:59], v[156:159], v[92:95]
    ds_read_b128 v[180:183], v16 offset:38912
    s_andn2_b32 s98, s29, 3
    v_mfma_f32_16x16x32_bf16 v[96:99], v[56:59], v[160:163], v[96:99]
    ds_read_b64_tr_b16 v[76:77], v26 offset:32768
    s_add_u32 s15, s98, s15
    v_mfma_f32_16x16x32_bf16 v[100:103], v[56:59], v[164:167], v[100:103]
    buffer_load_dwordx4 v[184:187], v10, s[68:71], s87 offen offset:0 sc1
    v_mfma_f32_16x16x32_bf16 a[252:255], v[56:59], a[224:227], a[252:255]
    buffer_load_dwordx4 v[188:191], v10, s[68:71], s87 offen offset:256 sc1
    v_mfma_f32_16x16x32_bf16 v[104:107], v[60:63], v[152:155], v[104:107]
    buffer_load_dwordx4 v[192:195], v10, s[68:71], s87 offen offset:512 sc1
    v_mfma_f32_16x16x32_bf16 v[108:111], v[60:63], v[156:159], v[108:111]
    buffer_load_dwordx4 v[196:199], v10, s[68:71], s87 offen offset:768 sc1
    v_mfma_f32_16x16x32_bf16 v[112:115], v[60:63], v[160:163], v[112:115]
    ds_read_b64_tr_b16 v[78:79], v26 offset:33280
    s_lshl2_add_u32 s15, s15, s3
    v_mfma_f32_16x16x32_bf16 v[116:119], v[60:63], v[164:167], v[116:119]
    buffer_load_dwordx4 v30, s[60:63], s85 offen offset:0 lds
    v_mfma_f32_16x16x32_bf16 a[252:255], v[60:63], a[228:231], a[252:255]
    ds_read_b64_tr_b16 v[80:81], v27 offset:32768
    v_add_u32 v15, 65536, v15
    s_waitcnt lgkmcnt(9)
    v_mfma_f32_16x16x32_bf16 v[120:123], v[64:67], v[152:155], v[120:123]
    ds_read_b64_tr_b16 v[82:83], v27 offset:33280
    v_add_u32 v21, 65536, v21
    v_mfma_f32_16x16x32_bf16 v[124:127], v[64:67], v[156:159], v[124:127]
    buffer_load_dwordx4 v31, s[60:63], s85 offen offset:1024 lds
    v_mfma_f32_16x16x32_bf16 v[128:131], v[64:67], v[160:163], v[128:131]
    ds_read_b64_tr_b16 v[84:85], v28 offset:32768
    v_add_u32 v22, 65536, v22
    v_mfma_f32_16x16x32_bf16 v[132:135], v[64:67], v[164:167], v[132:135]
    ds_read_b64_tr_b16 v[86:87], v28 offset:33280
    v_add_u32 v23, 65536, v23
    v_mfma_f32_16x16x32_bf16 a[252:255], v[64:67], a[232:235], a[252:255]
    buffer_load_dwordx4 v32, s[60:63], s85 offen offset:2048 lds
    v_mfma_f32_16x16x32_bf16 v[136:139], v[68:71], v[152:155], v[136:139]
    v_add_u32 v24, 65536, v24
    v_add_u32 v16, 65536, v16
    v_mfma_f32_16x16x32_bf16 v[140:143], v[68:71], v[156:159], v[140:143]
    v_add_u32 v25, 65536, v25
    v_add_u32 v26, 65536, v26
    v_mfma_f32_16x16x32_bf16 v[144:147], v[68:71], v[160:163], v[144:147]
    v_add_u32 v27, 65536, v27
    v_add_u32 v28, 65536, v28
    v_mfma_f32_16x16x32_bf16 v[148:151], v[68:71], v[164:167], v[148:151]
    s_mul_i32 s50, s15, 14336
    s_add_u32 s50, s50, 5242880
    v_mfma_f32_16x16x32_bf16 a[252:255], v[68:71], a[236:239], a[252:255]
    s_add_u32 s15, s3, 4
    s_and_b32 s15, s15, 3
    s_waitcnt lgkmcnt(4)
    v_mfma_f32_16x16x32_bf16 v[88:91], v[72:75], v[168:171], v[88:91]
    s_andn2_b32 s98, s29, 3
    s_add_u32 s15, s98, s15
    v_mfma_f32_16x16x32_bf16 v[92:95], v[72:75], v[172:175], v[92:95]
    s_lshl2_add_u32 s15, s15, s3
    s_mul_i32 s51, s15, 14336
    s_add_u32 s51, s51, 5242880
    s_waitcnt vmcnt(17) lgkmcnt(0)
    s_barrier
    s_waitcnt vmcnt(15)
    buffer_store_dwordx2 v[4:5], v3, s[68:71], s34 offen sc1
    v_mfma_f32_16x16x32_bf16 v[96:99], v[72:75], v[176:179], v[96:99]
    buffer_load_dwordx4 v33, s[60:63], s85 offen offset:3072 lds
    v_mfma_f32_16x16x32_bf16 v[100:103], v[72:75], v[180:183], v[100:103]
    ds_read_b128 v[152:155], v15 offset:0
    ds_read_b128 v[156:159], v15 offset:2048
    v_mfma_f32_16x16x32_bf16 v[104:107], v[76:79], v[168:171], v[104:107]
    ds_read_b64_tr_b16 v[56:57], v21 offset:0
    s_add_u32 m0, s100, 0
    v_mfma_f32_16x16x32_bf16 v[108:111], v[76:79], v[172:175], v[108:111]
    ds_read_b64_tr_b16 v[58:59], v21 offset:512
    s_mov_b32 s85, 65536
    v_mfma_f32_16x16x32_bf16 v[112:115], v[76:79], v[176:179], v[112:115]
    buffer_load_dwordx4 v30, s[60:63], s85 offen offset:0 lds
    v_mfma_f32_16x16x32_bf16 v[116:119], v[76:79], v[180:183], v[116:119]
    ds_read_b128 v[160:163], v15 offset:4096
    v_mov_b32 v204, 0
    v_mfma_f32_16x16x32_bf16 v[120:123], v[80:83], v[168:171], v[120:123]
    ds_read_b128 v[164:167], v15 offset:6144
    v_mov_b32 v205, 0
    v_mfma_f32_16x16x32_bf16 v[124:127], v[80:83], v[172:175], v[124:127]
    ds_read_b64_tr_b16 v[60:61], v22 offset:0
    v_xor_b32 v29, 2048, v47
    v_mfma_f32_16x16x32_bf16 v[128:131], v[80:83], v[176:179], v[128:131]
    ds_read_b64_tr_b16 v[62:63], v22 offset:512
    v_add_u32 v17, 0x10000, v34
    v_mfma_f32_16x16x32_bf16 v[132:135], v[80:83], v[180:183], v[132:135]
    buffer_load_dwordx4 v31, s[60:63], s85 offen offset:1024 lds
    v_mfma_f32_16x16x32_bf16 v[136:139], v[84:87], v[168:171], v[136:139]
    ds_read_b64_tr_b16 v[64:65], v23 offset:0
    v_lshlrev_b32 v200, 16, v234
    v_mfma_f32_16x16x32_bf16 v[140:143], v[84:87], v[172:175], v[140:143]
    ds_read_b64_tr_b16 v[66:67], v23 offset:512
    v_add_u32 v18, 0x10000, v35
    v_mfma_f32_16x16x32_bf16 v[144:147], v[84:87], v[176:179], v[144:147]
    buffer_load_dwordx4 v32, s[60:63], s85 offen offset:2048 lds
    v_mfma_f32_16x16x32_bf16 v[148:151], v[84:87], v[180:183], v[148:151]
    ds_read_b64_tr_b16 v[68:69], v24 offset:0
    ds_read_b64_tr_b16 v[70:71], v24 offset:512
    buffer_load_dwordx4 v33, s[60:63], s85 offen offset:3072 lds
    v_and_b32 v201, 0xffff0000, v234
    v_lshlrev_b32 v202, 16, v235
    v_and_b32 v203, 0xffff0000, v235
    v_add_u32 v19, 0x10000, v36
    v_add_u32 v20, 0x10000, v37
    ds_read_b128 v[168:171], v16 offset:0
    s_add_u32 m0, s100, 16384
    s_waitcnt lgkmcnt(5)
    v_mfma_f32_16x16x32_bf16 v[88:91], v[56:59], v[152:155], v[88:91]
    ds_read_b128 v[172:175], v16 offset:2048
    s_mov_b32 s85, 131072
    v_mfma_f32_16x16x32_bf16 v[92:95], v[56:59], v[156:159], v[92:95]
    ds_read_b64_tr_b16 v[72:73], v25 offset:0
    v_add_u32 v15, 65536, v15
    v_mfma_f32_16x16x32_bf16 v[96:99], v[56:59], v[160:163], v[96:99]
    ds_read_b64_tr_b16 v[74:75], v25 offset:512
    v_add_u32 v21, 65536, v21
    v_mfma_f32_16x16x32_bf16 v[100:103], v[56:59], v[164:167], v[100:103]
    buffer_load_dwordx4 v30, s[60:63], s85 offen offset:0 lds
    v_mfma_f32_16x16x32_bf16 a[252:255], v[56:59], a[224:227], a[252:255]
    ds_read_b128 v[176:179], v16 offset:4096
    s_waitcnt vmcnt(18)
    v_alignbit_b32 v216, v224, v232, 16
    v_mfma_f32_16x16x32_bf16 v[104:107], v[60:63], v[152:155], v[104:107]
    ds_read_b128 v[180:183], v16 offset:6144
    v_add_u32 v22, 65536, v22
    v_mfma_f32_16x16x32_bf16 v[108:111], v[60:63], v[156:159], v[108:111]
    ds_read_b64_tr_b16 v[76:77], v26 offset:0
    v_add_u32 v23, 65536, v23
    v_mfma_f32_16x16x32_bf16 v[112:115], v[60:63], v[160:163], v[112:115]
    ds_read_b64_tr_b16 v[78:79], v26 offset:512
    v_add_u32 v24, 65536, v24
    v_mfma_f32_16x16x32_bf16 v[116:119], v[60:63], v[164:167], v[116:119]
    buffer_load_dwordx4 v31, s[60:63], s85 offen offset:1024 lds
    v_mfma_f32_16x16x32_bf16 a[252:255], v[60:63], a[228:231], a[252:255]
    ds_read_b64_tr_b16 v[80:81], v27 offset:0
    v_alignbit_b32 v217, v225, v224, 16
    s_waitcnt lgkmcnt(9)
    v_mfma_f32_16x16x32_bf16 v[120:123], v[64:67], v[152:155], v[120:123]
    ds_read_b64_tr_b16 v[82:83], v27 offset:512
    v_add_u32 v16, 65536, v16
    v_mfma_f32_16x16x32_bf16 v[124:127], v[64:67], v[156:159], v[124:127]
    buffer_load_dwordx4 v32, s[60:63], s85 offen offset:2048 lds
    v_mfma_f32_16x16x32_bf16 v[128:131], v[64:67], v[160:163], v[128:131]
    buffer_load_dwordx4 v33, s[60:63], s85 offen offset:3072 lds
    v_mfma_f32_16x16x32_bf16 v[132:135], v[64:67], v[164:167], v[132:135]
    ds_read_b64_tr_b16 v[84:85], v28 offset:0
    v_alignbit_b32 v218, v226, v225, 16
    v_mfma_f32_16x16x32_bf16 a[252:255], v[64:67], a[232:235], a[252:255]
    ds_read_b64_tr_b16 v[86:87], v28 offset:512
    s_add_u32 m0, s100, 32768
    v_mfma_f32_16x16x32_bf16 v[136:139], v[68:71], v[152:155], v[136:139]
    s_mov_b32 s85, 196608
    v_add_u32 v25, 65536, v25
    v_mfma_f32_16x16x32_bf16 v[140:143], v[68:71], v[156:159], v[140:143]
    buffer_load_dwordx4 v30, s[60:63], s85 offen offset:0 lds
    v_mfma_f32_16x16x32_bf16 v[144:147], v[68:71], v[160:163], v[144:147]
    v_add_u32 v26, 65536, v26
    v_add_u32 v27, 65536, v27
    v_mfma_f32_16x16x32_bf16 v[148:151], v[68:71], v[164:167], v[148:151]
    v_alignbit_b32 v219, v227, v226, 16
    v_add_u32 v28, 65536, v28
    v_mfma_f32_16x16x32_bf16 a[252:255], v[68:71], a[236:239], a[252:255]
    s_waitcnt lgkmcnt(4)
    v_mfma_f32_16x16x32_bf16 v[88:91], v[72:75], v[168:171], v[88:91]
    v_mfma_f32_16x16x32_bf16 v[92:95], v[72:75], v[172:175], v[92:95]
    v_mfma_f32_16x16x32_bf16 v[96:99], v[72:75], v[176:179], v[96:99]
    v_mfma_f32_16x16x32_bf16 v[100:103], v[72:75], v[180:183], v[100:103]
    s_waitcnt vmcnt(18) lgkmcnt(0)
    s_barrier
    ds_read_b128 v[152:155], v15 offset:0
    ds_read_b128 v[156:159], v15 offset:2048
    v_mfma_f32_16x16x32_bf16 v[104:107], v[76:79], v[168:171], v[104:107]
    ds_read_b64_tr_b16 v[56:57], v21 offset:0
    v_mfma_f32_16x16x32_bf16 v[108:111], v[76:79], v[172:175], v[108:111]
    ds_read_b64_tr_b16 v[58:59], v21 offset:512
    v_mfma_f32_16x16x32_bf16 v[112:115], v[76:79], v[176:179], v[112:115]
    buffer_load_dwordx4 v31, s[60:63], s85 offen offset:1024 lds
    v_mfma_f32_16x16x32_bf16 v[116:119], v[76:79], v[180:183], v[116:119]
    buffer_load_dwordx4 v32, s[60:63], s85 offen offset:2048 lds
    v_mfma_f32_16x16x32_bf16 v[120:123], v[80:83], v[168:171], v[120:123]
    ds_read_b128 v[160:163], v15 offset:4096
    v_alignbit_b32 v220, v228, v233, 16
    v_mfma_f32_16x16x32_bf16 v[124:127], v[80:83], v[172:175], v[124:127]
    ds_read_b128 v[164:167], v15 offset:6144
    v_mfma_f32_16x16x32_bf16 v[128:131], v[80:83], v[176:179], v[128:131]
    ds_read_b64_tr_b16 v[60:61], v22 offset:0
    v_mfma_f32_16x16x32_bf16 v[132:135], v[80:83], v[180:183], v[132:135]
    ds_read_b64_tr_b16 v[62:63], v22 offset:512
    s_nop 0
    v_mfma_f32_16x16x32_bf16 v[136:139], v[84:87], v[168:171], v[136:139]
    buffer_load_dwordx4 v33, s[60:63], s85 offen offset:3072 lds
    v_mfma_f32_16x16x32_bf16 v[140:143], v[84:87], v[172:175], v[140:143]
    ds_read_b64_tr_b16 v[64:65], v23 offset:0
    v_alignbit_b32 v221, v229, v228, 16
    v_mfma_f32_16x16x32_bf16 v[144:147], v[84:87], v[176:179], v[144:147]
    ds_read_b64_tr_b16 v[66:67], v23 offset:512
    s_add_u32 m0, s100, 49152
    v_mfma_f32_16x16x32_bf16 v[148:151], v[84:87], v[180:183], v[148:151]
    ds_read_b64_tr_b16 v[68:69], v24 offset:0
    ds_read_b64_tr_b16 v[70:71], v24 offset:512
    ds_read_b128 v[168:171], v16 offset:0
    ds_read_b128 v[172:175], v16 offset:2048
    ds_read_b64_tr_b16 v[72:73], v25 offset:0
    s_mov_b32 s85, 262144
    buffer_load_dwordx4 v30, s[60:63], s85 offen offset:0 lds
    ds_read_b64_tr_b16 v[74:75], v25 offset:512
    v_alignbit_b32 v222, v230, v229, 16
    v_alignbit_b32 v223, v231, v230, 16
    buffer_load_dwordx4 v31, s[60:63], s85 offen offset:1024 lds
    s_waitcnt lgkmcnt(8)
    v_mfma_f32_16x16x32_bf16 v[88:91], v[56:59], v[152:155], v[88:91]
    buffer_load_dwordx4 v32, s[60:63], s85 offen offset:2048 lds
    v_mfma_f32_16x16x32_bf16 v[92:95], v[56:59], v[156:159], v[92:95]
    ds_write_b128 v48, v[200:203] offset:1024
    v_mfma_f32_16x16x32_bf16 v[96:99], v[56:59], v[160:163], v[96:99]
    ds_read_b128 v[176:179], v16 offset:4096
    v_mfma_f32_16x16x32_bf16 v[100:103], v[56:59], v[164:167], v[100:103]
    ds_read_b128 v[180:183], v16 offset:6144
    s_waitcnt vmcnt(20)
    v_cmp_ne_u64 vcc, s[6:7], v[186:187]
    v_mfma_f32_16x16x32_bf16 a[252:255], v[56:59], a[224:227], a[252:255]
    v_cmp_ne_u64 s[90:91], s[6:7], v[190:191]
    ds_read_b64_tr_b16 v[76:77], v26 offset:0
    s_or_b64 vcc, vcc, s[90:91]
    v_cmp_ne_u64 s[90:91], s[6:7], v[194:195]
    s_nop 0
    s_or_b64 vcc, vcc, s[90:91]
    v_cmp_ne_u64 s[90:91], s[6:7], v[198:199]
    s_nop 0
    s_or_b64 vcc, vcc, s[90:91]
    s_cbranch_vccnz Lslow_stat
Lback_stat:
    buffer_load_dwordx4 v33, s[60:63], s85 offen offset:3072 lds
    s_waitcnt vmcnt(16)
    ds_read_b64_tr_b16 a[0:1], v17 offset:32768
    ds_read_b64_tr_b16 a[4:5], v18 offset:32768
    ds_read_b64_tr_b16 a[8:9], v19 offset:32768
    v_mfma_f32_16x16x32_bf16 v[104:107], v[60:63], v[152:155], v[104:107]
    ds_read_b64_tr_b16 a[12:13], v20 offset:32768
    v_mul_f32 v236, v185, v185
    v_mfma_f32_16x16x32_bf16 v[108:111], v[60:63], v[156:159], v[108:111]
    ds_read_b64_tr_b16 v[78:79], v26 offset:512
    v_mul_f32 v236, 0x3727c5ac, v236
    v_mfma_f32_16x16x32_bf16 v[112:115], v[60:63], v[160:163], v[112:115]
    ds_read_b64_tr_b16 a[2:3], v17 offset:34816
    v_sub_f32 v236, 0x3f800054, v236
    v_mfma_f32_16x16x32_bf16 v[116:119], v[60:63], v[164:167], v[116:119]
    ds_read_b64_tr_b16 a[6:7], v18 offset:34816
    s_add_u32 m0, s100, 98304
    v_mfma_f32_16x16x32_bf16 a[252:255], v[60:63], a[228:231], a[252:255]
    ds_read_b64_tr_b16 a[10:11], v19 offset:34816
    s_mov_b32 s85, 327680
    s_waitcnt lgkmcnt(15)
    v_mfma_f32_16x16x32_bf16 v[120:123], v[64:67], v[152:155], v[120:123]
    ds_read_b64_tr_b16 a[14:15], v20 offset:34816
    v_mul_f32 v237, v189, v189
    v_mfma_f32_16x16x32_bf16 v[124:127], v[64:67], v[156:159], v[124:127]
    ds_read_b64_tr_b16 v[80:81], v27 offset:0
    v_mul_f32 v237, 0x3727c5ac, v237
    v_mfma_f32_16x16x32_bf16 v[128:131], v[64:67], v[160:163], v[128:131]
    v_rsq_f32 v236, v236
    v_sub_f32 v237, 0x3f800054, v237
    v_mul_f32 v236, v236, v185
    v_mul_f32_e64 v240, -v236, v184
    v_rsq_f32 v237, v237
    ds_read_b64_tr_b16 v[82:83], v27 offset:512
    v_mul_f32 v237, v237, v189
    v_mul_f32_e64 v241, -v237, v188
    v_mul_f32 v238, v193, v193
    v_mul_f32 v238, 0x3727c5ac, v238
    v_sub_f32 v238, 0x3f800054, v238
    v_rsq_f32 v238, v238
    ds_read_b64_tr_b16 v[84:85], v28 offset:0
    ds_read_b64_tr_b16 v[86:87], v28 offset:512
    v_mul_f32 v238, v238, v193
    v_mul_f32_e64 v242, -v238, v192
    v_mul_f32 v239, v197, v197
    v_mul_f32 v239, 0x3727c5ac, v239
    v_sub_f32 v239, 0x3f800054, v239
    s_waitcnt lgkmcnt(4)
    buffer_load_dwordx4 v30, s[60:63], s85 offen offset:0 lds
    v_mfma_f32_16x16x32_bf16 v[132:135], v[64:67], v[164:167], v[132:135]
    buffer_load_dwordx4 v31, s[60:63], s85 offen offset:1024 lds
    v_mfma_f32_16x16x32_bf16 a[252:255], v[64:67], a[232:235], a[252:255]
    buffer_load_dwordx4 v32, s[60:63], s85 offen offset:2048 lds
    v_mfma_f32_16x16x32_bf16 v[136:139], v[68:71], v[152:155], v[136:139]
    buffer_load_dwordx4 v33, s[60:63], s85 offen offset:3072 lds
    v_mfma_f32_16x16x32_bf16 v[140:143], v[68:71], v[156:159], v[140:143]
    s_waitcnt vmcnt(16)
    ds_read_b64_tr_b16 a[16:17], v34 offset:0
    s_add_u32 m0, s100, 0
    v_mfma_f32_16x16x32_bf16 v[144:147], v[68:71], v[160:163], v[144:147]
    ds_read_b64_tr_b16 a[20:21], v35 offset:0
    s_mov_b32 s85, 393216
    v_mfma_f32_16x16x32_bf16 v[148:151], v[68:71], v[164:167], v[148:151]
    ds_read_b64_tr_b16 a[24:25], v36 offset:0
    v_mfma_f32_16x16x32_bf16 a[252:255], v[68:71], a[236:239], a[252:255]
    ds_read_b64_tr_b16 a[28:29], v37 offset:0
    v_mfma_f32_16x16x32_bf16 v[88:91], v[72:75], v[168:171], v[88:91]
    ds_read_b64_tr_b16 a[18:19], v34 offset:2048
    v_mfma_f32_16x16x32_bf16 v[92:95], v[72:75], v[172:175], v[92:95]
    ds_read_b64_tr_b16 a[22:23], v35 offset:2048
    v_mfma_f32_16x16x32_bf16 v[96:99], v[72:75], v[176:179], v[96:99]
    ds_read_b64_tr_b16 a[26:27], v36 offset:2048
    v_mfma_f32_16x16x32_bf16 v[100:103], v[72:75], v[180:183], v[100:103]
    ds_read_b64_tr_b16 a[30:31], v37 offset:2048
    v_mfma_f32_16x16x32_bf16 v[104:107], v[76:79], v[168:171], v[104:107]
    ds_write_b128 v48, a[252:255]
    v_mfma_f32_16x16x32_bf16 v[108:111], v[76:79], v[172:175], v[108:111]
    v_rsq_f32 v239, v239
    v_mfma_f32_16x16x32_bf16 v[112:115], v[76:79], v[176:179], v[112:115]
    v_mul_f32 v239, v239, v197
    v_mul_f32_e64 v243, -v239, v196
    s_waitcnt lgkmcnt(1)
    buffer_load_dwordx4 v30, s[60:63], s85 offen offset:0 lds
    v_mfma_f32_16x16x32_bf16 v[116:119], v[76:79], v[180:183], v[116:119]
    buffer_load_dwordx4 v31, s[60:63], s85 offen offset:1024 lds
    s_waitcnt lgkmcnt(0)
    s_barrier
    buffer_load_dwordx2 v[6:7], v8, s[68:71], 0 offen sc1
    ds_read_b128 v[152:155], v47 offset:0
    ds_read_b128 v[156:159], v47 offset:64
    ds_read_b128 v[160:163], v47 offset:128
    v_mfma_f32_16x16x32_bf16 v[120:123], v[80:83], v[168:171], v[120:123]
    ds_read_b128 v[164:167], v47 offset:192
    v_mfma_f32_16x16x32_bf16 v[124:127], v[80:83], v[172:175], v[124:127]
    ds_read_b128 v[56:59], v29 offset:0
    v_mfma_f32_16x16x32_bf16 v[128:131], v[80:83], v[176:179], v[128:131]
    ds_read_b128 v[60:63], v29 offset:64
    v_mfma_f32_16x16x32_bf16 v[132:135], v[80:83], v[180:183], v[132:135]
    ds_read_b128 v[64:67], v29 offset:128
    v_mfma_f32_16x16x32_bf16 v[136:139], v[84:87], v[168:171], v[136:139]
    ds_read_b128 v[68:71], v29 offset:192
    v_mfma_f32_16x16x32_bf16 v[140:143], v[84:87], v[172:175], v[140:143]
    ds_read_b128 v[184:187], v47 offset:1024
    v_mfma_f32_16x16x32_bf16 v[144:147], v[84:87], v[176:179], v[144:147]
    buffer_load_dwordx4 v32, s[60:63], s85 offen offset:2048 lds
    ds_read_b128 v[188:191], v47 offset:1088
    v_mfma_f32_16x16x32_bf16 v[148:151], v[84:87], v[180:183], v[148:151]
    ds_read_b128 v[192:195], v47 offset:1152
    ds_read_b128 v[196:199], v47 offset:1216
    buffer_load_dwordx4 v33, s[60:63], s85 offen offset:3072 lds
    s_waitcnt vmcnt(17)
    ds_read_b64_tr_b16 a[32:33], v34 offset:16384
    ds_read_b64_tr_b16 a[36:37], v35 offset:16384
    ds_read_b64_tr_b16 a[40:41], v36 offset:16384
    ds_read_b64_tr_b16 a[44:45], v37 offset:16384
    ds_read_b64_tr_b16 a[34:35], v34 offset:18432
    s_waitcnt lgkmcnt(12)
    v_add_f32 v152, v152, v56
    v_add_f32 v153, v153, v57
    v_add_f32 v154, v154, v58
    v_add_f32 v155, v155, v59
    s_waitcnt lgkmcnt(11)
    v_add_f32 v156, v156, v60
    v_add_f32 v157, v157, v61
    ds_read_b64_tr_b16 a[38:39], v35 offset:18432
    ds_read_b64_tr_b16 a[42:43], v36 offset:18432
    ds_read_b64_tr_b16 a[46:47], v37 offset:18432
    v_add_f32 v158, v158, v62
    v_add_f32 v159, v159, v63
    s_add_u32 m0, s100, 16384
    s_mov_b32 s85, 229376
    s_waitcnt lgkmcnt(13)
    v_add_f32 v160, v160, v64
    v_add_f32 v161, v161, v65
    v_add_f32 v162, v162, v66
    v_add_f32 v163, v163, v67
    s_waitcnt lgkmcnt(12)
    v_add_f32 v164, v164, v68
    v_add_f32 v165, v165, v69
    v_add_f32 v166, v166, v70
    v_add_f32 v167, v167, v71
    s_waitcnt lgkmcnt(11)
    v_pk_fma_f32 v[56:57], v[152:153], v[240:241], v[184:185] op_sel:[0,0,0] op_sel_hi:[1,0,1]
    v_pk_fma_f32 v[64:65], v[154:155], v[240:241], v[186:187] op_sel:[0,0,0] op_sel_hi:[1,0,1]
    s_waitcnt lgkmcnt(10)
    v_pk_fma_f32 v[72:73], v[156:157], v[240:241], v[188:189] op_sel:[0,0,0] op_sel_hi:[1,0,1]
    v_pk_fma_f32 v[80:81], v[158:159], v[240:241], v[190:191] op_sel:[0,0,0] op_sel_hi:[1,0,1]
    v_pk_fma_f32 v[56:57], v[88:89], v[236:237], v[56:57] op_sel:[0,0,0] op_sel_hi:[1,0,1]
    v_pk_fma_f32 v[64:65], v[90:91], v[236:237], v[64:65] op_sel:[0,0,0] op_sel_hi:[1,0,1]
    v_pk_fma_f32 v[72:73], v[104:105], v[236:237], v[72:73] op_sel:[0,0,0] op_sel_hi:[1,0,1]
    v_pk_fma_f32 v[80:81], v[106:107], v[236:237], v[80:81] op_sel:[0,0,0] op_sel_hi:[1,0,1]
    v_pk_mul_f32 v[58:59], v[56:57], v[56:57]
    v_pk_mul_f32 v[66:67], v[64:65], v[64:65]
    v_pk_mul_f32 v[74:75], v[72:73], v[72:73]
    v_pk_mul_f32 v[82:83], v[80:81], v[80:81]
    v_pk_fma_f32 v[58:59], v[58:59], s[82:83], s[82:83] op_sel:[0,1,0] op_sel_hi:[1,1,0]
    v_pk_fma_f32 v[66:67], v[66:67], s[82:83], s[82:83] op_sel:[0,1,0] op_sel_hi:[1,1,0]
    v_pk_fma_f32 v[74:75], v[74:75], s[82:83], s[82:83] op_sel:[0,1,0] op_sel_hi:[1,1,0]
    v_pk_fma_f32 v[82:83], v[82:83], s[82:83], s[82:83] op_sel:[0,1,0] op_sel_hi:[1,1,0]
    v_pk_mul_f32 v[58:59], v[58:59], v[56:57]
    v_pk_mul_f32 v[66:67], v[66:67], v[64:65]
    v_pk_mul_f32 v[74:75], v[74:75], v[72:73]
    v_pk_mul_f32 v[82:83], v[82:83], v[80:81]
    v_exp_f32 v60, v58
    s_waitcnt lgkmcnt(0)
    buffer_load_dwordx4 v30, s[60:63], s85 offen offset:0 lds
    v_exp_f32 v68, v66
    v_exp_f32 v76, v74
    v_exp_f32 v84, v82
    s_waitcnt vmcnt(3)
    v_cmp_ne_u64 vcc, s[6:7], v[6:7]
    v_exp_f32 v61, v59
    v_exp_f32 v69, v67
    v_exp_f32 v77, v75
    s_nop 1
    s_cbranch_vccnz Lslow_kv
Lback_kv:
    buffer_load_dwordx4 v[208:211], v1, s[68:71], s31 offen offset:0 sc1
    v_exp_f32 v85, v83
    v_pk_add_f32 v[60:61], v[60:61], 1.0 op_sel_hi:[1,0]
    v_pk_add_f32 v[68:69], v[68:69], 1.0 op_sel_hi:[1,0]
    v_pk_add_f32 v[76:77], v[76:77], 1.0 op_sel_hi:[1,0]
    v_pk_add_f32 v[84:85], v[84:85], 1.0 op_sel_hi:[1,0]
    v_rcp_f32 v62, v60
    v_rcp_f32 v70, v68
    v_rcp_f32 v78, v76
    v_rcp_f32 v86, v84
    v_rcp_f32 v63, v61
    v_rcp_f32 v71, v69
    v_rcp_f32 v79, v77
    v_rcp_f32 v87, v85
    v_pk_mul_f32 v[62:63], v[62:63], v[56:57]
    v_pk_mul_f32 v[70:71], v[70:71], v[64:65]
    v_pk_mul_f32 v[78:79], v[78:79], v[72:73]
    v_pk_mul_f32 v[86:87], v[86:87], v[80:81]
    v_cvt_pk_bf16_f32 v168, v62, v63
    v_cvt_pk_bf16_f32 v169, v70, v71
    v_cvt_pk_bf16_f32 v170, v78, v79
    v_cvt_pk_bf16_f32 v171, v86, v87
    buffer_store_dwordx4 v[168:171], v1, s[68:71], s16 offen offset:0 sc1
    v_pk_fma_f32 v[56:57], v[152:153], v[240:241], v[184:185] op_sel:[0,1,0] op_sel_hi:[1,1,1]
    v_pk_fma_f32 v[64:65], v[154:155], v[240:241], v[186:187] op_sel:[0,1,0] op_sel_hi:[1,1,1]
    v_pk_fma_f32 v[72:73], v[156:157], v[240:241], v[188:189] op_sel:[0,1,0] op_sel_hi:[1,1,1]
    v_pk_fma_f32 v[80:81], v[158:159], v[240:241], v[190:191] op_sel:[0,1,0] op_sel_hi:[1,1,1]
    v_pk_fma_f32 v[56:57], v[92:93], v[236:237], v[56:57] op_sel:[0,1,0] op_sel_hi:[1,1,1]
    v_pk_fma_f32 v[64:65], v[94:95], v[236:237], v[64:65] op_sel:[0,1,0] op_sel_hi:[1,1,1]
    v_pk_fma_f32 v[72:73], v[108:109], v[236:237], v[72:73] op_sel:[0,1,0] op_sel_hi:[1,1,1]
    v_pk_fma_f32 v[80:81], v[110:111], v[236:237], v[80:81] op_sel:[0,1,0] op_sel_hi:[1,1,1]
    v_pk_mul_f32 v[58:59], v[56:57], v[56:57]
    v_pk_mul_f32 v[66:67], v[64:65], v[64:65]
    v_pk_mul_f32 v[74:75], v[72:73], v[72:73]
    v_pk_mul_f32 v[82:83], v[80:81], v[80:81]
    v_pk_fma_f32 v[58:59], v[58:59], s[82:83], s[82:83] op_sel:[0,1,0] op_sel_hi:[1,1,0]
    v_pk_fma_f32 v[66:67], v[66:67], s[82:83], s[82:83] op_sel:[0,1,0] op_sel_hi:[1,1,0]
    v_pk_fma_f32 v[74:75], v[74:75], s[82:83], s[82:83] op_sel:[0,1,0] op_sel_hi:[1,1,0]
    v_pk_fma_f32 v[82:83], v[82:83], s[82:83], s[82:83] op_sel:[0,1,0] op_sel_hi:[1,1,0]
    v_pk_mul_f32 v[58:59], v[58:59], v[56:57]
    v_pk_mul_f32 v[66:67], v[66:67], v[64:65]
    v_pk_mul_f32 v[74:75], v[74:75], v[72:73]
    v_pk_mul_f32 v[82:83], v[82:83], v[80:81]
    v_exp_f32 v60, v58
    v_exp_f32 v68, v66
    v_exp_f32 v76, v74
    v_exp_f32 v84, v82
    v_exp_f32 v61, v59
    v_exp_f32 v69, v67
    v_exp_f32 v77, v75
    v_exp_f32 v85, v83
    v_pk_add_f32 v[60:61], v[60:61], 1.0 op_sel_hi:[1,0]
    v_pk_add_f32 v[68:69], v[68:69], 1.0 op_sel_hi:[1,0]
    v_pk_add_f32 v[76:77], v[76:77], 1.0 op_sel_hi:[1,0]
    v_pk_add_f32 v[84:85], v[84:85], 1.0 op_sel_hi:[1,0]
    v_rcp_f32 v62, v60
    v_rcp_f32 v70, v68
    v_rcp_f32 v78, v76
    v_rcp_f32 v86, v84
    v_rcp_f32 v63, v61
    v_rcp_f32 v71, v69
    v_rcp_f32 v79, v77
    v_rcp_f32 v87, v85
    v_pk_mul_f32 v[62:63], v[62:63], v[56:57]
    v_pk_mul_f32 v[70:71], v[70:71], v[64:65]
    v_pk_mul_f32 v[78:79], v[78:79], v[72:73]
    v_pk_mul_f32 v[86:87], v[86:87], v[80:81]
    v_cvt_pk_bf16_f32 v172, v62, v63
    v_cvt_pk_bf16_f32 v173, v70, v71
    v_cvt_pk_bf16_f32 v174, v78, v79
    v_cvt_pk_bf16_f32 v175, v86, v87
    buffer_store_dwordx4 v[172:175], v1, s[68:71], s17 offen offset:0 sc1
    ds_write_b128 v252, v[216:219]
    v_pk_fma_f32 v[56:57], v[152:153], v[242:243], v[184:185] op_sel:[0,0,0] op_sel_hi:[1,0,1]
    v_pk_fma_f32 v[64:65], v[154:155], v[242:243], v[186:187] op_sel:[0,0,0] op_sel_hi:[1,0,1]
    v_pk_fma_f32 v[72:73], v[156:157], v[242:243], v[188:189] op_sel:[0,0,0] op_sel_hi:[1,0,1]
    v_pk_fma_f32 v[80:81], v[158:159], v[242:243], v[190:191] op_sel:[0,0,0] op_sel_hi:[1,0,1]
    v_pk_fma_f32 v[56:57], v[96:97], v[238:239], v[56:57] op_sel:[0,0,0] op_sel_hi:[1,0,1]
    v_pk_fma_f32 v[64:65], v[98:99], v[238:239], v[64:65] op_sel:[0,0,0] op_sel_hi:[1,0,1]
    v_pk_fma_f32 v[72:73], v[112:113], v[238:239], v[72:73] op_sel:[0,0,0] op_sel_hi:[1,0,1]
    v_pk_fma_f32 v[80:81], v[114:115], v[238:239], v[80:81] op_sel:[0,0,0] op_sel_hi:[1,0,1]
    v_pk_mul_f32 v[58:59], v[56:57], v[56:57]
    v_pk_mul_f32 v[66:67], v[64:65], v[64:65]
    v_pk_mul_f32 v[74:75], v[72:73], v[72:73]
    v_pk_mul_f32 v[82:83], v[80:81], v[80:81]
    v_pk_fma_f32 v[58:59], v[58:59], s[82:83], s[82:83] op_sel:[0,1,0] op_sel_hi:[1,1,0]
    v_pk_fma_f32 v[66:67], v[66:67], s[82:83], s[82:83] op_sel:[0,1,0] op_sel_hi:[1,1,0]
    v_pk_fma_f32 v[74:75], v[74:75], s[82:83], s[82:83] op_sel:[0,1,0] op_sel_hi:[1,1,0]
    v_pk_fma_f32 v[82:83], v[82:83], s[82:83], s[82:83] op_sel:[0,1,0] op_sel_hi:[1,1,0]
    v_pk_mul_f32 v[58:59], v[58:59], v[56:57]
    v_pk_mul_f32 v[66:67], v[66:67], v[64:65]
    v_pk_mul_f32 v[74:75], v[74:75], v[72:73]
    v_pk_mul_f32 v[82:83], v[82:83], v[80:81]
    v_exp_f32 v60, v58
    v_exp_f32 v68, v66
    v_exp_f32 v76, v74
    v_exp_f32 v84, v82
    buffer_load_dwordx4 v[212:215], v1, s[68:71], s31 offen offset:1024 sc1
    v_exp_f32 v61, v59
    v_exp_f32 v69, v67
    v_exp_f32 v77, v75
    v_exp_f32 v85, v83
    v_pk_add_f32 v[60:61], v[60:61], 1.0 op_sel_hi:[1,0]
    v_pk_add_f32 v[68:69], v[68:69], 1.0 op_sel_hi:[1,0]
    v_pk_add_f32 v[76:77], v[76:77], 1.0 op_sel_hi:[1,0]
    v_pk_add_f32 v[84:85], v[84:85], 1.0 op_sel_hi:[1,0]
    v_rcp_f32 v62, v60
    v_rcp_f32 v70, v68
    v_rcp_f32 v78, v76
    v_rcp_f32 v86, v84
    v_rcp_f32 v63, v61
    v_rcp_f32 v71, v69
    v_rcp_f32 v79, v77
    v_rcp_f32 v87, v85
    v_pk_mul_f32 v[62:63], v[62:63], v[56:57]
    v_pk_mul_f32 v[70:71], v[70:71], v[64:65]
    v_pk_mul_f32 v[78:79], v[78:79], v[72:73]
    v_pk_mul_f32 v[86:87], v[86:87], v[80:81]
    v_cvt_pk_bf16_f32 v176, v62, v63
    v_cvt_pk_bf16_f32 v177, v70, v71
    v_cvt_pk_bf16_f32 v178, v78, v79
    v_cvt_pk_bf16_f32 v179, v86, v87
    buffer_store_dwordx4 v[176:179], v1, s[68:71], s18 offen offset:0 sc1
    ds_write_b128 v252, v[220:223] offset:1024
    v_pk_fma_f32 v[56:57], v[152:153], v[242:243], v[184:185] op_sel:[0,1,0] op_sel_hi:[1,1,1]
    v_pk_fma_f32 v[64:65], v[154:155], v[242:243], v[186:187] op_sel:[0,1,0] op_sel_hi:[1,1,1]
    v_pk_fma_f32 v[72:73], v[156:157], v[242:243], v[188:189] op_sel:[0,1,0] op_sel_hi:[1,1,1]
    v_pk_fma_f32 v[80:81], v[158:159], v[242:243], v[190:191] op_sel:[0,1,0] op_sel_hi:[1,1,1]
    v_pk_fma_f32 v[56:57], v[100:101], v[238:239], v[56:57] op_sel:[0,1,0] op_sel_hi:[1,1,1]
    v_pk_fma_f32 v[64:65], v[102:103], v[238:239], v[64:65] op_sel:[0,1,0] op_sel_hi:[1,1,1]
    v_pk_fma_f32 v[72:73], v[116:117], v[238:239], v[72:73] op_sel:[0,1,0] op_sel_hi:[1,1,1]
    v_pk_fma_f32 v[80:81], v[118:119], v[238:239], v[80:81] op_sel:[0,1,0] op_sel_hi:[1,1,1]
    v_pk_mul_f32 v[58:59], v[56:57], v[56:57]
    v_pk_mul_f32 v[66:67], v[64:65], v[64:65]
    v_pk_mul_f32 v[74:75], v[72:73], v[72:73]
    v_pk_mul_f32 v[82:83], v[80:81], v[80:81]
    v_pk_fma_f32 v[58:59], v[58:59], s[82:83], s[82:83] op_sel:[0,1,0] op_sel_hi:[1,1,0]
    v_pk_fma_f32 v[66:67], v[66:67], s[82:83], s[82:83] op_sel:[0,1,0] op_sel_hi:[1,1,0]
    v_pk_fma_f32 v[74:75], v[74:75], s[82:83], s[82:83] op_sel:[0,1,0] op_sel_hi:[1,1,0]
    v_pk_fma_f32 v[82:83], v[82:83], s[82:83], s[82:83] op_sel:[0,1,0] op_sel_hi:[1,1,0]
    v_pk_mul_f32 v[58:59], v[58:59], v[56:57]
    v_pk_mul_f32 v[66:67], v[66:67], v[64:65]
    v_pk_mul_f32 v[74:75], v[74:75], v[72:73]
    v_pk_mul_f32 v[82:83], v[82:83], v[80:81]
    v_exp_f32 v60, v58
    v_exp_f32 v68, v66
    v_exp_f32 v76, v74
    v_exp_f32 v84, v82
    buffer_load_dwordx4 v31, s[60:63], s85 offen offset:1024 lds
    v_exp_f32 v61, v59
    v_exp_f32 v69, v67
    v_exp_f32 v77, v75
    v_exp_f32 v85, v83
    v_pk_add_f32 v[60:61], v[60:61], 1.0 op_sel_hi:[1,0]
    v_pk_add_f32 v[68:69], v[68:69], 1.0 op_sel_hi:[1,0]
    v_pk_add_f32 v[76:77], v[76:77], 1.0 op_sel_hi:[1,0]
    v_pk_add_f32 v[84:85], v[84:85], 1.0 op_sel_hi:[1,0]
    v_rcp_f32 v62, v60
    v_rcp_f32 v70, v68
    v_rcp_f32 v78, v76
    v_rcp_f32 v86, v84
    v_rcp_f32 v63, v61
    v_rcp_f32 v71, v69
    v_rcp_f32 v79, v77
    v_rcp_f32 v87, v85
    v_pk_mul_f32 v[62:63], v[62:63], v[56:57]
    v_pk_mul_f32 v[70:71], v[70:71], v[64:65]
    v_pk_mul_f32 v[78:79], v[78:79], v[72:73]
    v_pk_mul_f32 v[86:87], v[86:87], v[80:81]
    v_cvt_pk_bf16_f32 v180, v62, v63
    v_cvt_pk_bf16_f32 v181, v70, v71
    v_cvt_pk_bf16_f32 v182, v78, v79
    v_cvt_pk_bf16_f32 v183, v86, v87
    buffer_store_dwordx4 v[180:183], v1, s[68:71], s19 offen offset:0 sc1
    ds_write_b128 v252, v[224:227] offset:4160
    v_pk_fma_f32 v[56:57], v[160:161], v[240:241], v[192:193] op_sel:[0,0,0] op_sel_hi:[1,0,1]
    v_pk_fma_f32 v[64:65], v[162:163], v[240:241], v[194:195] op_sel:[0,0,0] op_sel_hi:[1,0,1]
    v_pk_fma_f32 v[72:73], v[164:165], v[240:241], v[196:197] op_sel:[0,0,0] op_sel_hi:[1,0,1]
    v_pk_fma_f32 v[80:81], v[166:167], v[240:241], v[198:199] op_sel:[0,0,0] op_sel_hi:[1,0,1]
    v_pk_fma_f32 v[56:57], v[120:121], v[236:237], v[56:57] op_sel:[0,0,0] op_sel_hi:[1,0,1]
    v_pk_fma_f32 v[64:65], v[122:123], v[236:237], v[64:65] op_sel:[0,0,0] op_sel_hi:[1,0,1]
    v_pk_fma_f32 v[72:73], v[136:137], v[236:237], v[72:73] op_sel:[0,0,0] op_sel_hi:[1,0,1]
    v_pk_fma_f32 v[80:81], v[138:139], v[236:237], v[80:81] op_sel:[0,0,0] op_sel_hi:[1,0,1]
    v_pk_mul_f32 v[58:59], v[56:57], v[56:57]
    v_pk_mul_f32 v[66:67], v[64:65], v[64:65]
    v_pk_mul_f32 v[74:75], v[72:73], v[72:73]
    v_pk_mul_f32 v[82:83], v[80:81], v[80:81]
    v_pk_fma_f32 v[58:59], v[58:59], s[82:83], s[82:83] op_sel:[0,1,0] op_sel_hi:[1,1,0]
    v_pk_fma_f32 v[66:67], v[66:67], s[82:83], s[82:83] op_sel:[0,1,0] op_sel_hi:[1,1,0]
    v_pk_fma_f32 v[74:75], v[74:75], s[82:83], s[82:83] op_sel:[0,1,0] op_sel_hi:[1,1,0]
    v_pk_fma_f32 v[82:83], v[82:83], s[82:83], s[82:83] op_sel:[0,1,0] op_sel_hi:[1,1,0]
    v_pk_mul_f32 v[58:59], v[58:59], v[56:57]
    v_pk_mul_f32 v[66:67], v[66:67], v[64:65]
    v_pk_mul_f32 v[74:75], v[74:75], v[72:73]
    v_pk_mul_f32 v[82:83], v[82:83], v[80:81]
    v_exp_f32 v60, v58
    v_exp_f32 v68, v66
    v_exp_f32 v76, v74
    v_exp_f32 v84, v82
    buffer_load_dwordx4 v32, s[60:63], s85 offen offset:2048 lds
    v_exp_f32 v61, v59
    v_exp_f32 v69, v67
    v_exp_f32 v77, v75
    v_exp_f32 v85, v83
    v_pk_add_f32 v[60:61], v[60:61], 1.0 op_sel_hi:[1,0]
    v_pk_add_f32 v[68:69], v[68:69], 1.0 op_sel_hi:[1,0]
    v_pk_add_f32 v[76:77], v[76:77], 1.0 op_sel_hi:[1,0]
    v_pk_add_f32 v[84:85], v[84:85], 1.0 op_sel_hi:[1,0]
    v_rcp_f32 v62, v60
    v_rcp_f32 v70, v68
    v_rcp_f32 v78, v76
    v_rcp_f32 v86, v84
    v_rcp_f32 v63, v61
    v_rcp_f32 v71, v69
    v_rcp_f32 v79, v77
    v_rcp_f32 v87, v85
    v_pk_mul_f32 v[62:63], v[62:63], v[56:57]
    v_pk_mul_f32 v[70:71], v[70:71], v[64:65]
    v_pk_mul_f32 v[78:79], v[78:79], v[72:73]
    v_pk_mul_f32 v[86:87], v[86:87], v[80:81]
    v_cvt_pk_bf16_f32 v168, v62, v63
    v_cvt_pk_bf16_f32 v169, v70, v71
    v_cvt_pk_bf16_f32 v170, v78, v79
    v_cvt_pk_bf16_f32 v171, v86, v87
    buffer_store_dwordx4 v[168:171], v1, s[68:71], s16 offen offset:1024 sc1
    ds_write_b128 v252, v[228:231] offset:5184
    v_pk_fma_f32 v[56:57], v[160:161], v[240:241], v[192:193] op_sel:[0,1,0] op_sel_hi:[1,1,1]
    v_pk_fma_f32 v[64:65], v[162:163], v[240:241], v[194:195] op_sel:[0,1,0] op_sel_hi:[1,1,1]
    v_pk_fma_f32 v[72:73], v[164:165], v[240:241], v[196:197] op_sel:[0,1,0] op_sel_hi:[1,1,1]
    v_pk_fma_f32 v[80:81], v[166:167], v[240:241], v[198:199] op_sel:[0,1,0] op_sel_hi:[1,1,1]
    v_pk_fma_f32 v[56:57], v[124:125], v[236:237], v[56:57] op_sel:[0,1,0] op_sel_hi:[1,1,1]
    v_pk_fma_f32 v[64:65], v[126:127], v[236:237], v[64:65] op_sel:[0,1,0] op_sel_hi:[1,1,1]
    v_pk_fma_f32 v[72:73], v[140:141], v[236:237], v[72:73] op_sel:[0,1,0] op_sel_hi:[1,1,1]
    v_pk_fma_f32 v[80:81], v[142:143], v[236:237], v[80:81] op_sel:[0,1,0] op_sel_hi:[1,1,1]
    v_pk_mul_f32 v[58:59], v[56:57], v[56:57]
    v_pk_mul_f32 v[66:67], v[64:65], v[64:65]
    v_pk_mul_f32 v[74:75], v[72:73], v[72:73]
    v_pk_mul_f32 v[82:83], v[80:81], v[80:81]
    v_pk_fma_f32 v[58:59], v[58:59], s[82:83], s[82:83] op_sel:[0,1,0] op_sel_hi:[1,1,0]
    v_pk_fma_f32 v[66:67], v[66:67], s[82:83], s[82:83] op_sel:[0,1,0] op_sel_hi:[1,1,0]
    v_pk_fma_f32 v[74:75], v[74:75], s[82:83], s[82:83] op_sel:[0,1,0] op_sel_hi:[1,1,0]
    v_pk_fma_f32 v[82:83], v[82:83], s[82:83], s[82:83] op_sel:[0,1,0] op_sel_hi:[1,1,0]
    v_pk_mul_f32 v[58:59], v[58:59], v[56:57]
    v_pk_mul_f32 v[66:67], v[66:67], v[64:65]
    v_pk_mul_f32 v[74:75], v[74:75], v[72:73]
    v_pk_mul_f32 v[82:83], v[82:83], v[80:81]
    v_exp_f32 v60, v58
    v_exp_f32 v68, v66
    v_exp_f32 v76, v74
    v_exp_f32 v84, v82
    buffer_load_dwordx4 v33, s[60:63], s85 offen offset:3072 lds
    v_exp_f32 v61, v59
    v_exp_f32 v69, v67
    v_exp_f32 v77, v75
    v_exp_f32 v85, v83
    v_pk_add_f32 v[60:61], v[60:61], 1.0 op_sel_hi:[1,0]
    v_pk_add_f32 v[68:69], v[68:69], 1.0 op_sel_hi:[1,0]
    v_pk_add_f32 v[76:77], v[76:77], 1.0 op_sel_hi:[1,0]
    v_pk_add_f32 v[84:85], v[84:85], 1.0 op_sel_hi:[1,0]
    v_rcp_f32 v62, v60
    v_rcp_f32 v70, v68
    v_rcp_f32 v78, v76
    v_rcp_f32 v86, v84
    v_rcp_f32 v63, v61
    v_rcp_f32 v71, v69
    v_rcp_f32 v79, v77
    v_rcp_f32 v87, v85
    v_pk_mul_f32 v[62:63], v[62:63], v[56:57]
    v_pk_mul_f32 v[70:71], v[70:71], v[64:65]
    v_pk_mul_f32 v[78:79], v[78:79], v[72:73]
    v_pk_mul_f32 v[86:87], v[86:87], v[80:81]
    v_cvt_pk_bf16_f32 v172, v62, v63
    v_cvt_pk_bf16_f32 v173, v70, v71
    v_cvt_pk_bf16_f32 v174, v78, v79
    v_cvt_pk_bf16_f32 v175, v86, v87
    buffer_store_dwordx4 v[172:175], v1, s[68:71], s17 offen offset:1024 sc1
    ds_write_b64 v253, v[204:205] offset:4096
    ds_read_b64_tr_b16 a[64:65], v34 offset:49152
    ds_read_b64_tr_b16 a[68:69], v35 offset:49152
    ds_read_b64_tr_b16 a[72:73], v36 offset:49152
    ds_read_b64_tr_b16 a[76:77], v37 offset:49152
    v_pk_fma_f32 v[56:57], v[160:161], v[242:243], v[192:193] op_sel:[0,0,0] op_sel_hi:[1,0,1]
    v_pk_fma_f32 v[64:65], v[162:163], v[242:243], v[194:195] op_sel:[0,0,0] op_sel_hi:[1,0,1]
    v_pk_fma_f32 v[72:73], v[164:165], v[242:243], v[196:197] op_sel:[0,0,0] op_sel_hi:[1,0,1]
    v_pk_fma_f32 v[80:81], v[166:167], v[242:243], v[198:199] op_sel:[0,0,0] op_sel_hi:[1,0,1]
    v_pk_fma_f32 v[56:57], v[128:129], v[238:239], v[56:57] op_sel:[0,0,0] op_sel_hi:[1,0,1]
    v_pk_fma_f32 v[64:65], v[130:131], v[238:239], v[64:65] op_sel:[0,0,0] op_sel_hi:[1,0,1]
    v_pk_fma_f32 v[72:73], v[144:145], v[238:239], v[72:73] op_sel:[0,0,0] op_sel_hi:[1,0,1]
    v_pk_fma_f32 v[80:81], v[146:147], v[238:239], v[80:81] op_sel:[0,0,0] op_sel_hi:[1,0,1]
    v_pk_mul_f32 v[58:59], v[56:57], v[56:57]
    v_pk_mul_f32 v[66:67], v[64:65], v[64:65]
    v_pk_mul_f32 v[74:75], v[72:73], v[72:73]
    v_pk_mul_f32 v[82:83], v[80:81], v[80:81]
    v_pk_fma_f32 v[58:59], v[58:59], s[82:83], s[82:83] op_sel:[0,1,0] op_sel_hi:[1,1,0]
    v_pk_fma_f32 v[66:67], v[66:67], s[82:83], s[82:83] op_sel:[0,1,0] op_sel_hi:[1,1,0]
    v_pk_fma_f32 v[74:75], v[74:75], s[82:83], s[82:83] op_sel:[0,1,0] op_sel_hi:[1,1,0]
    v_pk_fma_f32 v[82:83], v[82:83], s[82:83], s[82:83] op_sel:[0,1,0] op_sel_hi:[1,1,0]
    v_pk_mul_f32 v[58:59], v[58:59], v[56:57]
    v_pk_mul_f32 v[66:67], v[66:67], v[64:65]
    v_pk_mul_f32 v[74:75], v[74:75], v[72:73]
    v_pk_mul_f32 v[82:83], v[82:83], v[80:81]
    v_exp_f32 v60, v58
    v_exp_f32 v68, v66
    v_exp_f32 v76, v74
    v_exp_f32 v84, v82
    ds_read_b64_tr_b16 a[66:67], v34 offset:51200
    ds_read_b64_tr_b16 a[70:71], v35 offset:51200
    ds_read_b64_tr_b16 a[74:75], v36 offset:51200
    ds_read_b64_tr_b16 a[78:79], v37 offset:51200
    s_add_u32 m0, s100, 49152
    s_mov_b32 s85, 294912
    v_exp_f32 v61, v59
    v_exp_f32 v69, v67
    v_exp_f32 v77, v75
    v_exp_f32 v85, v83
    v_pk_add_f32 v[60:61], v[60:61], 1.0 op_sel_hi:[1,0]
    v_pk_add_f32 v[68:69], v[68:69], 1.0 op_sel_hi:[1,0]
    v_pk_add_f32 v[76:77], v[76:77], 1.0 op_sel_hi:[1,0]
    v_pk_add_f32 v[84:85], v[84:85], 1.0 op_sel_hi:[1,0]
    v_rcp_f32 v62, v60
    v_rcp_f32 v70, v68
    v_rcp_f32 v78, v76
    v_rcp_f32 v86, v84
    v_rcp_f32 v63, v61
    v_rcp_f32 v71, v69
    v_rcp_f32 v79, v77
    v_rcp_f32 v87, v85
    v_pk_mul_f32 v[62:63], v[62:63], v[56:57]
    v_pk_mul_f32 v[70:71], v[70:71], v[64:65]
    v_pk_mul_f32 v[78:79], v[78:79], v[72:73]
    v_pk_mul_f32 v[86:87], v[86:87], v[80:81]
    s_waitcnt lgkmcnt(0)
    buffer_load_dwordx4 v30, s[60:63], s85 offen offset:0 lds
    ds_write_b64 v254, v[204:205]
    v_cvt_pk_bf16_f32 v176, v62, v63
    v_cvt_pk_bf16_f32 v177, v70, v71
    v_cvt_pk_bf16_f32 v178, v78, v79
    v_cvt_pk_bf16_f32 v179, v86, v87
    buffer_store_dwordx4 v[176:179], v1, s[68:71], s18 offen offset:1024 sc1
    v_pk_fma_f32 v[56:57], v[160:161], v[242:243], v[192:193] op_sel:[0,1,0] op_sel_hi:[1,1,1]
    v_pk_fma_f32 v[64:65], v[162:163], v[242:243], v[194:195] op_sel:[0,1,0] op_sel_hi:[1,1,1]
    v_pk_fma_f32 v[72:73], v[164:165], v[242:243], v[196:197] op_sel:[0,1,0] op_sel_hi:[1,1,1]
    v_pk_fma_f32 v[80:81], v[166:167], v[242:243], v[198:199] op_sel:[0,1,0] op_sel_hi:[1,1,1]
    v_pk_fma_f32 v[56:57], v[132:133], v[238:239], v[56:57] op_sel:[0,1,0] op_sel_hi:[1,1,1]
    v_pk_fma_f32 v[64:65], v[134:135], v[238:239], v[64:65] op_sel:[0,1,0] op_sel_hi:[1,1,1]
    v_pk_fma_f32 v[72:73], v[148:149], v[238:239], v[72:73] op_sel:[0,1,0] op_sel_hi:[1,1,1]
    v_pk_fma_f32 v[80:81], v[150:151], v[238:239], v[80:81] op_sel:[0,1,0] op_sel_hi:[1,1,1]
    v_pk_mul_f32 v[58:59], v[56:57], v[56:57]
    v_pk_mul_f32 v[66:67], v[64:65], v[64:65]
    v_pk_mul_f32 v[74:75], v[72:73], v[72:73]
    v_pk_mul_f32 v[82:83], v[80:81], v[80:81]
    v_pk_fma_f32 v[58:59], v[58:59], s[82:83], s[82:83] op_sel:[0,1,0] op_sel_hi:[1,1,0]
    v_pk_fma_f32 v[66:67], v[66:67], s[82:83], s[82:83] op_sel:[0,1,0] op_sel_hi:[1,1,0]
    v_pk_fma_f32 v[74:75], v[74:75], s[82:83], s[82:83] op_sel:[0,1,0] op_sel_hi:[1,1,0]
    v_pk_fma_f32 v[82:83], v[82:83], s[82:83], s[82:83] op_sel:[0,1,0] op_sel_hi:[1,1,0]
    v_pk_mul_f32 v[58:59], v[58:59], v[56:57]
    v_pk_mul_f32 v[66:67], v[66:67], v[64:65]
    v_pk_mul_f32 v[74:75], v[74:75], v[72:73]
    v_pk_mul_f32 v[82:83], v[82:83], v[80:81]
    v_exp_f32 v60, v58
    v_exp_f32 v68, v66
    v_exp_f32 v76, v74
    v_exp_f32 v84, v82
    buffer_load_dwordx4 v31, s[60:63], s85 offen offset:1024 lds
    v_exp_f32 v61, v59
    v_exp_f32 v69, v67
    v_exp_f32 v77, v75
    v_exp_f32 v85, v83
    v_pk_add_f32 v[60:61], v[60:61], 1.0 op_sel_hi:[1,0]
    v_pk_add_f32 v[68:69], v[68:69], 1.0 op_sel_hi:[1,0]
    v_pk_add_f32 v[76:77], v[76:77], 1.0 op_sel_hi:[1,0]
    v_pk_add_f32 v[84:85], v[84:85], 1.0 op_sel_hi:[1,0]
    v_rcp_f32 v62, v60
    v_rcp_f32 v70, v68
    v_rcp_f32 v78, v76
    v_rcp_f32 v86, v84
    v_rcp_f32 v63, v61
    v_rcp_f32 v71, v69
    v_rcp_f32 v79, v77
    v_rcp_f32 v87, v85
    v_pk_mul_f32 v[62:63], v[62:63], v[56:57]
    v_pk_mul_f32 v[70:71], v[70:71], v[64:65]
    v_pk_mul_f32 v[78:79], v[78:79], v[72:73]
    v_pk_mul_f32 v[86:87], v[86:87], v[80:81]
    v_cvt_pk_bf16_f32 v180, v62, v63
    v_cvt_pk_bf16_f32 v181, v70, v71
    v_cvt_pk_bf16_f32 v182, v78, v79
    v_cvt_pk_bf16_f32 v183, v86, v87
    buffer_store_dwordx4 v[180:183], v1, s[68:71], s19 offen offset:1024 sc1
    s_waitcnt vmcnt(11)
    ds_write_b128 v51, v[208:211]
    ds_write_b128 v51, v[212:215] offset:1024
    s_lshr_b32 s15, s29, 2
    s_lshl2_add_u32 s15, s15, s3
    s_mul_i32 s15, s15, 896
    s_add_u32 s15, s15, 131072
    v_lshrrev_b32 v28, 3, v0
    v_min_u32 v28, 6, v28
    v_lshl_add_u32 v8, v28, 7, s15
    s_lshl_b32 s15, s3, 10
    s_sub_u32 s98, 143096, s15
    v_sub_u32 v53, s98, v2
    s_add_u32 s15, s100, 65536
    s_waitcnt lgkmcnt(0)
    s_barrier
    ds_read2_b32 v[88:89], v38 offset0:0 offset1:1
    ds_read2_b32 v[90:91], v38 offset0:2 offset1:3
    ds_read_b128 v[120:123], v42 offset:3584
    ds_read2_b32 v[92:93], v38 offset0:128 offset1:129
    ds_read2_b32 v[94:95], v38 offset0:130 offset1:131
    ds_read_b128 v[124:127], v42 offset:3072
    ds_read2_b32 v[96:97], v39 offset0:0 offset1:1
    ds_read2_b32 v[98:99], v39 offset0:2 offset1:3
    ds_read_b128 v[128:131], v42 offset:2560
    ds_read2_b32 v[100:101], v39 offset0:128 offset1:129
    ds_read2_b32 v[102:103], v39 offset0:130 offset1:131
    ds_read_b128 v[132:135], v42 offset:2048
    s_waitcnt vmcnt(8)
    buffer_store_dwordx2 v[4:5], v3, s[68:71], s30 offen sc1
    ds_read2_b32 v[104:105], v40 offset0:0 offset1:1
    buffer_load_dwordx4 v32, s[60:63], s85 offen offset:2048 lds
    ds_read2_b32 v[106:107], v40 offset0:2 offset1:3
    ds_read_b128 v[136:139], v42 offset:1536
    ds_read2_b32 v[108:109], v40 offset0:128 offset1:129
    ds_read2_b32 v[110:111], v40 offset0:130 offset1:131
    ds_read_b128 v[140:143], v42 offset:1024
    ds_read2_b32 v[112:113], v41 offset0:0 offset1:1
    ds_read2_b32 v[114:115], v41 offset0:2 offset1:3
    ds_read_b128 v[144:147], v42 offset:512
    ds_read2_b32 v[116:117], v41 offset0:128 offset1:129
    buffer_load_dwordx4 v33, s[60:63], s85 offen offset:3072 lds
    ds_read2_b32 v[118:119], v41 offset0:130 offset1:131
    s_add_u32 s30, s30, 655360
    ds_read_b64_tr_b16 a[48:49], v34 offset:32768
    ds_read_b64_tr_b16 a[52:53], v35 offset:32768
    ds_read_b64_tr_b16 a[56:57], v36 offset:32768
    s_waitcnt lgkmcnt(15)
    v_mfma_f32_16x16x32_bf16 v[56:59], v[88:91], v[120:123], 0
    ds_read_b64_tr_b16 a[60:61], v37 offset:32768
    s_add_u32 m0, s100, 32768
    v_mfma_f32_16x16x32_bf16 v[60:63], v[88:91], v[124:127], 0
    ds_read_b128 v[148:151], v42 offset:0
    s_mov_b32 s85, 425984
    v_mfma_f32_16x16x32_bf16 v[60:63], v[92:95], v[120:123], v[60:63]
    ds_read_b64_tr_b16 a[50:51], v34 offset:34816
    v_lshrrev_b32 v24, 4, v0
    v_mfma_f32_16x16x32_bf16 v[64:67], v[92:95], v[124:127], 0
    ds_read_b64_tr_b16 a[54:55], v35 offset:34816
    v_lshl_add_u32 v24, v24, 6, v1
    v_mfma_f32_16x16x32_bf16 v[64:67], v[88:91], v[128:131], v[64:67]
    ds_read_b64_tr_b16 a[58:59], v36 offset:34816
    v_add_u32 v52, s15, v24
    v_mfma_f32_16x16x32_bf16 v[64:67], v[96:99], v[120:123], v[64:67]
    ds_read_b64_tr_b16 a[62:63], v37 offset:34816
    v_and_b32 v24, 3, v0
    v_mfma_f32_16x16x32_bf16 v[68:71], v[92:95], v[128:131], 0
    ds_read2_b32 v[152:153], v38 offset0:16 offset1:17
    v_mul_u32_u24 v24, 320, v24
    v_mfma_f32_16x16x32_bf16 v[68:71], v[96:99], v[124:127], v[68:71]
    ds_read2_b32 v[154:155], v38 offset0:18 offset1:19
    ds_read_b128 v[184:187], v42 offset:3648
    ds_read2_b32 v[156:157], v38 offset0:144 offset1:145
    ds_read2_b32 v[158:159], v38 offset0:146 offset1:147
    ds_read_b128 v[188:191], v42 offset:3136
    ds_read2_b32 v[160:161], v39 offset0:16 offset1:17
    ds_read2_b32 v[162:163], v39 offset0:18 offset1:19
    ds_read_b128 v[192:195], v42 offset:2624
    v_lshrrev_b32 v25, 2, v0
    v_lshl_add_u32 v24, v25, 4, v24
    s_lshl1_add_u32 s15, s3, 0
    s_mul_i32 s98, s15, 11
    s_lshr_b32 s98, s98, 5
    s_mul_i32 s98, s98, 12544
    s_mul_i32 s15, s15, 1280
    s_add_u32 s15, s15, s98
    s_add_u32 s15, s15, 65536
    v_add_u32 v54, s15, v24
    s_lshl1_add_u32 s15, s3, 1
    s_mul_i32 s98, s15, 11
    s_lshr_b32 s98, s98, 5
    s_mul_i32 s98, s98, 12544
    s_mul_i32 s15, s15, 1280
    s_add_u32 s15, s15, s98
    s_add_u32 s15, s15, 65536
    s_waitcnt lgkmcnt(9)
    buffer_load_dwordx4 v30, s[60:63], s85 offen offset:0 lds
    v_mfma_f32_16x16x32_bf16 v[72:75], v[96:99], v[128:131], 0
    buffer_load_dwordx4 v31, s[60:63], s85 offen offset:1024 lds
    v_mfma_f32_16x16x32_bf16 v[68:71], v[88:91], v[132:135], v[68:71]
    buffer_load_dwordx4 v32, s[60:63], s85 offen offset:2048 lds
    v_mfma_f32_16x16x32_bf16 v[68:71], v[100:103], v[120:123], v[68:71]
    buffer_load_dwordx4 v33, s[60:63], s85 offen offset:3072 lds
    v_mfma_f32_16x16x32_bf16 v[72:75], v[92:95], v[132:135], v[72:75]
    ds_read_b64_tr_b16 a[80:81], v17 offset:32768
    ds_read_b64_tr_b16 a[84:85], v18 offset:32768
    v_mfma_f32_16x16x32_bf16 v[72:75], v[100:103], v[124:127], v[72:75]
    ds_read_b64_tr_b16 a[88:89], v19 offset:32768
    s_add_u32 m0, s100, 98304
    v_mfma_f32_16x16x32_bf16 v[76:79], v[96:99], v[132:135], 0
    ds_read_b64_tr_b16 a[92:93], v20 offset:32768
    s_mov_b32 s85, 163840
    v_mfma_f32_16x16x32_bf16 v[76:79], v[100:103], v[128:131], v[76:79]
    ds_read_b64_tr_b16 a[82:83], v17 offset:34816
    v_add_u32 v55, s15, v24
    v_mfma_f32_16x16x32_bf16 v[80:83], v[100:103], v[132:135], 0
    ds_read_b64_tr_b16 a[86:87], v18 offset:34816
    s_mov_b32 s97, 655360
    v_mfma_f32_16x16x32_bf16 v[72:75], v[88:91], v[136:139], v[72:75]
    ds_read_b64_tr_b16 a[90:91], v19 offset:34816
    v_mfma_f32_16x16x32_bf16 v[72:75], v[104:107], v[120:123], v[72:75]
    ds_read_b64_tr_b16 a[94:95], v20 offset:34816
    v_mfma_f32_16x16x32_bf16 v[76:79], v[92:95], v[136:139], v[76:79]
    ds_read2_b32 v[164:165], v39 offset0:144 offset1:145
    v_mfma_f32_16x16x32_bf16 v[76:79], v[104:107], v[124:127], v[76:79]
    ds_read2_b32 v[166:167], v39 offset0:146 offset1:147
    ds_read_b128 v[196:199], v42 offset:2112
    ds_read2_b32 v[168:169], v40 offset0:16 offset1:17
    ds_read2_b32 v[170:171], v40 offset0:18 offset1:19
    ds_read_b128 v[200:203], v42 offset:1600
    ds_read2_b32 v[172:173], v40 offset0:144 offset1:145
    ds_read2_b32 v[174:175], v40 offset0:146 offset1:147
    ds_read_b128 v[204:207], v42 offset:1088
    ds_read2_b32 v[176:177], v41 offset0:16 offset1:17
    s_waitcnt lgkmcnt(10)
    buffer_load_dwordx4 v30, s[60:63], s85 offen offset:0 lds
    v_mfma_f32_16x16x32_bf16 v[80:83], v[96:99], v[136:139], v[80:83]
    buffer_load_dwordx4 v31, s[60:63], s85 offen offset:1024 lds
    v_mfma_f32_16x16x32_bf16 v[80:83], v[104:107], v[128:131], v[80:83]
    buffer_load_dwordx4 v32, s[60:63], s85 offen offset:2048 lds
    v_mfma_f32_16x16x32_bf16 v[84:87], v[100:103], v[136:139], 0
    buffer_load_dwordx4 v33, s[60:63], s85 offen offset:3072 lds
    v_mfma_f32_16x16x32_bf16 v[84:87], v[104:107], v[132:135], v[84:87]
    ds_read2_b32 v[178:179], v41 offset0:18 offset1:19
    s_add_u32 m0, s100, 65536
    v_mfma_f32_16x16x32_bf16 v[76:79], v[88:91], v[140:143], v[76:79]
    s_mov_b32 s85, 32768
    v_mfma_f32_16x16x32_bf16 v[76:79], v[108:111], v[120:123], v[76:79]
    ds_read_b128 v[208:211], v42 offset:576
    v_mfma_f32_16x16x32_bf16 v[80:83], v[92:95], v[140:143], v[80:83]
    buffer_load_dwordx4 v30, s[60:63], s85 offen offset:0 lds
    v_mfma_f32_16x16x32_bf16 v[80:83], v[108:111], v[124:127], v[80:83]
    ds_read2_b32 v[180:181], v41 offset0:144 offset1:145
    v_mfma_f32_16x16x32_bf16 v[84:87], v[96:99], v[140:143], v[84:87]
    ds_read2_b32 v[182:183], v41 offset0:146 offset1:147
    v_mfma_f32_16x16x32_bf16 v[84:87], v[108:111], v[128:131], v[84:87]
    ds_read_b128 v[212:215], v42 offset:64
    v_mfma_f32_16x16x32_bf16 v[80:83], v[88:91], v[144:147], v[80:83]
    s_waitcnt vmcnt(12)
    buffer_store_dwordx2 v[4:5], v3, s[68:71], s30 offen sc1
    v_mfma_f32_16x16x32_bf16 v[80:83], v[112:115], v[120:123], v[80:83]
    ds_read_b64 v[216:217], v53 offset:512
    v_mfma_f32_16x16x32_bf16 v[84:87], v[92:95], v[144:147], v[84:87]
    buffer_load_dwordx4 v31, s[60:63], s85 offen offset:1024 lds
    v_mfma_f32_16x16x32_bf16 v[84:87], v[112:115], v[124:127], v[84:87]
    ds_read_b64 v[218:219], v53 offset:5120
    s_lshl_b32 s15, s29, 14
    v_mfma_f32_16x16x32_bf16 v[84:87], v[88:91], v[148:151], v[84:87]
    ds_read_b64 v[220:221], v53 offset:0
    s_lshl_b32 s98, s13, 7
    v_mfma_f32_16x16x32_bf16 v[84:87], v[116:119], v[120:123], v[84:87]
    ds_read_b64 v[222:223], v53 offset:4608
    buffer_load_dwordx4 v32, s[60:63], s85 offen offset:2048 lds
    ds_read2_b32 v[88:89], v38 offset0:32 offset1:33
    ds_read2_b32 v[90:91], v38 offset0:34 offset1:35
    ds_read_b128 v[120:123], v42 offset:3712
    s_add_u32 s15, s15, s98
    v_lshrrev_b32 v28, 4, v0
    v_lshl_add_u32 v16, v28, 3, s98
    s_waitcnt lgkmcnt(7)
    v_mfma_f32_16x16x32_bf16 v[56:59], v[152:155], v[184:187], v[56:59]
    buffer_load_dwordx4 v33, s[60:63], s85 offen offset:3072 lds
    v_mfma_f32_16x16x32_bf16 v[60:63], v[152:155], v[188:191], v[60:63]
    ds_read2_b32 v[92:93], v38 offset0:160 offset1:161
    s_add_u32 m0, s100, 81920
    v_mfma_f32_16x16x32_bf16 v[60:63], v[156:159], v[184:187], v[60:63]
    ds_read2_b32 v[94:95], v38 offset0:162 offset1:163
    s_waitcnt lgkmcnt(8)
    v_and_b32 v224, 0xffff0000, v217
    v_mfma_f32_16x16x32_bf16 v[64:67], v[156:159], v[188:191], v[64:67]
    ds_read_b128 v[124:127], v42 offset:3200
    v_lshlrev_b32 v225, 16, v217
    v_mfma_f32_16x16x32_bf16 v[64:67], v[152:155], v[192:195], v[64:67]
    ds_read2_b32 v[96:97], v39 offset0:32 offset1:33
    v_and_b32 v226, 0xffff0000, v216
    v_mfma_f32_16x16x32_bf16 v[64:67], v[160:163], v[184:187], v[64:67]
    ds_read2_b32 v[98:99], v39 offset0:34 offset1:35
    v_lshlrev_b32 v227, 16, v216
    v_mfma_f32_16x16x32_bf16 v[68:71], v[156:159], v[192:195], v[68:71]
    v_mul_f32 v224, s94, v224
    v_mul_f32 v225, s94, v225
    v_mfma_f32_16x16x32_bf16 v[68:71], v[160:163], v[188:191], v[68:71]
    ds_read_b128 v[128:131], v42 offset:2688
    v_mul_f32 v226, s94, v226
    v_mfma_f32_16x16x32_bf16 v[72:75], v[160:163], v[192:195], v[72:75]
    ds_read2_b32 v[100:101], v39 offset0:160 offset1:161
    v_mul_f32 v227, s94, v227
    v_mfma_f32_16x16x32_bf16 v[68:71], v[152:155], v[196:199], v[68:71]
    ds_read2_b32 v[102:103], v39 offset0:162 offset1:163
    s_mov_b32 s85, 98304
    v_mfma_f32_16x16x32_bf16 v[68:71], v[164:167], v[184:187], v[68:71]
    buffer_load_dwordx4 v30, s[60:63], s85 offen offset:0 lds
    v_mfma_f32_16x16x32_bf16 v[72:75], v[156:159], v[196:199], v[72:75]
    buffer_load_dwordx2 v[6:7], v8, s[68:71], 0 offen sc1
    v_mfma_f32_16x16x32_bf16 v[72:75], v[164:167], v[188:191], v[72:75]
    ds_read_b128 v[132:135], v42 offset:2176
    s_waitcnt lgkmcnt(14)
    v_and_b32 v228, 0xffff0000, v219
    v_mfma_f32_16x16x32_bf16 v[76:79], v[160:163], v[196:199], v[76:79]
    buffer_load_dwordx4 v31, s[60:63], s85 offen offset:1024 lds
    v_mfma_f32_16x16x32_bf16 v[76:79], v[164:167], v[192:195], v[76:79]
    ds_read2_b32 v[104:105], v40 offset0:32 offset1:33
    v_lshlrev_b32 v229, 16, v219
    v_mfma_f32_16x16x32_bf16 v[80:83], v[164:167], v[196:199], v[80:83]
    ds_read2_b32 v[106:107], v40 offset0:34 offset1:35
    v_and_b32 v230, 0xffff0000, v218
    v_mfma_f32_16x16x32_bf16 v[72:75], v[152:155], v[200:203], v[72:75]
    ds_read_b128 v[136:139], v42 offset:1664
    v_lshlrev_b32 v231, 16, v218
    v_mfma_f32_16x16x32_bf16 v[72:75], v[168:171], v[184:187], v[72:75]
    ds_read2_b32 v[108:109], v40 offset0:160 offset1:161
    v_mul_f32 v228, s95, v228
    v_mfma_f32_16x16x32_bf16 v[76:79], v[156:159], v[200:203], v[76:79]
    buffer_load_dwordx4 v32, s[60:63], s85 offen offset:2048 lds
    v_mfma_f32_16x16x32_bf16 v[76:79], v[168:171], v[188:191], v[76:79]
    ds_read2_b32 v[110:111], v40 offset0:162 offset1:163
    v_mul_f32 v229, s95, v229
    v_mfma_f32_16x16x32_bf16 v[80:83], v[160:163], v[200:203], v[80:83]
    ds_read_b128 v[140:143], v42 offset:1152
    v_mul_f32 v230, s95, v230
    v_mfma_f32_16x16x32_bf16 v[80:83], v[168:171], v[192:195], v[80:83]
    ds_read2_b32 v[112:113], v41 offset0:32 offset1:33
    v_mul_f32 v231, s95, v231
    v_mfma_f32_16x16x32_bf16 v[84:87], v[164:167], v[200:203], v[84:87]
    buffer_load_dwordx4 v33, s[60:63], s85 offen offset:3072 lds
    v_mfma_f32_16x16x32_bf16 v[84:87], v[168:171], v[196:199], v[84:87]
    ds_read_b64_tr_b16 a[96:97], v34 offset:0
    s_waitcnt lgkmcnt(15)
    v_and_b32 v232, 0xffff0000, v221
    v_mfma_f32_16x16x32_bf16 v[76:79], v[152:155], v[204:207], v[76:79]
    v_lshlrev_b32 v233, 16, v221
    v_and_b32 v234, 0xffff0000, v220
    v_lshlrev_b32 v235, 16, v220
    v_mul_f32 v232, s94, v232
    v_mul_f32 v233, s94, v233
    v_mul_f32 v234, s94, v234
    ds_read_b64_tr_b16 a[100:101], v35 offset:0
    ds_read_b64_tr_b16 a[104:105], v36 offset:0
    v_mfma_f32_16x16x32_bf16 v[76:79], v[172:175], v[184:187], v[76:79]
    ds_read_b64_tr_b16 a[108:109], v37 offset:0
    v_mul_f32 v235, s94, v235
    v_mfma_f32_16x16x32_bf16 v[80:83], v[156:159], v[204:207], v[80:83]
    ds_read2_b32 v[114:115], v41 offset0:34 offset1:35
    s_add_u32 m0, s100, 0
    v_mfma_f32_16x16x32_bf16 v[80:83], v[172:175], v[188:191], v[80:83]
    ds_read_b64_tr_b16 a[98:99], v34 offset:2048
    s_mov_b32 s85, 360448
    v_mfma_f32_16x16x32_bf16 v[84:87], v[160:163], v[204:207], v[84:87]
    ds_read_b64_tr_b16 a[102:103], v35 offset:2048
    v_and_b32 v236, 0xffff0000, v223
    v_mfma_f32_16x16x32_bf16 v[84:87], v[172:175], v[192:195], v[84:87]
    ds_read_b64_tr_b16 a[106:107], v36 offset:2048
    v_lshlrev_b32 v237, 16, v223
    v_mfma_f32_16x16x32_bf16 v[80:83], v[152:155], v[208:211], v[80:83]
    ds_read_b64_tr_b16 a[110:111], v37 offset:2048
    v_and_b32 v238, 0xffff0000, v222
    v_mfma_f32_16x16x32_bf16 v[80:83], v[176:179], v[184:187], v[80:83]
    ds_read_b128 v[144:147], v42 offset:640
    v_lshlrev_b32 v239, 16, v222
    v_mfma_f32_16x16x32_bf16 v[84:87], v[156:159], v[208:211], v[84:87]
    ds_read2_b32 v[116:117], v41 offset0:160 offset1:161
    v_mul_f32 v236, s95, v236
    v_mfma_f32_16x16x32_bf16 v[84:87], v[176:179], v[188:191], v[84:87]
    ds_read2_b32 v[118:119], v41 offset0:162 offset1:163
    ds_read_b128 v[148:151], v42 offset:128
    v_mul_f32 v237, s95, v237
    v_mul_f32 v238, s95, v238
    v_mul_f32 v239, s95, v239
    v_xor_b32 v28, v0, v28
    v_and_b32 v28, 7, v28
    v_lshl_add_u32 v28, v28, 4, s15
    v_lshrrev_b32 v29, 3, v0
    v_lshl_add_u32 v11, v29, 10, v28
    v_xor_b32 v28, 64, v11
    v_add_u32 v12, 0x2000, v28
    v_lshrrev_b32 v29, 2, v0
    v_lshlrev_b32 v29, 13, v29
    v_and_b32 v28, 3, v0
    v_lshl_add_u32 v15, v28, 4, v29
    s_lshl_b32 s15, s29, 6
    s_lshl_b32 s98, s13, 18
    s_add_u32 s15, s15, s98
    s_add_u32 s78, s15, 3145728
    s_add_u32 s79, s15, 3276800
    s_lshl_b32 s15, s13, 14
    s_waitcnt lgkmcnt(4)
    buffer_load_dwordx4 v30, s[60:63], s85 offen offset:0 lds
    v_mfma_f32_16x16x32_bf16 v[84:87], v[152:155], v[212:215], v[84:87]
    buffer_load_dwordx4 v31, s[60:63], s85 offen offset:1024 lds
    v_mfma_f32_16x16x32_bf16 v[84:87], v[180:183], v[184:187], v[84:87]
    buffer_load_dwordx4 v32, s[60:63], s85 offen offset:2048 lds
    buffer_load_dwordx4 v33, s[60:63], s85 offen offset:3072 lds
    s_lshr_b32 s98, s10, 2
    s_lshl_b32 s98, s98, 7
    s_waitcnt lgkmcnt(0)
    v_mfma_f32_16x16x32_bf16 v[56:59], v[88:91], v[120:123], v[56:59]
    ds_read2_b32 v[152:153], v38 offset0:48 offset1:49
    s_add_u32 s15, s15, s98
    v_mfma_f32_16x16x32_bf16 v[60:63], v[88:91], v[124:127], v[60:63]
    ds_read2_b32 v[154:155], v38 offset0:50 offset1:51
    s_add_u32 s15, s15, 262144
    v_mfma_f32_16x16x32_bf16 v[60:63], v[92:95], v[120:123], v[60:63]
    ds_read_b128 v[184:187], v42 offset:3776
    v_lshrrev_b32 v29, 1, v0
    v_mfma_f32_16x16x32_bf16 v[64:67], v[92:95], v[124:127], v[64:67]
    ds_read2_b32 v[156:157], v38 offset0:176 offset1:177
    v_lshl_add_u32 v23, v29, 9, s15
    v_mfma_f32_16x16x32_bf16 v[64:67], v[88:91], v[128:131], v[64:67]
    s_add_u32 s15, s100, 49152
    v_add_u32 v13, s15, v1
    v_mfma_f32_16x16x32_bf16 v[64:67], v[96:99], v[120:123], v[64:67]
    s_waitcnt vmcnt(14)
    ds_read_b64_tr_b16 a[144:145], v17 offset:32768
    v_lshrrev_b32 v29, 3, v0
    v_mfma_f32_16x16x32_bf16 v[68:71], v[92:95], v[128:131], v[68:71]
    ds_read_b64_tr_b16 a[148:149], v18 offset:32768
    ds_read_b64_tr_b16 a[152:153], v19 offset:32768
    v_mfma_f32_16x16x32_bf16 v[68:71], v[96:99], v[124:127], v[68:71]
    ds_read_b64_tr_b16 a[156:157], v20 offset:32768
    v_lshlrev_b32 v29, 6, v29
    v_mfma_f32_16x16x32_bf16 v[72:75], v[96:99], v[128:131], v[72:75]
    ds_read_b64_tr_b16 a[146:147], v17 offset:34816
    v_lshl_add_u32 v29, v28, 4, v29
    v_mfma_f32_16x16x32_bf16 v[68:71], v[88:91], v[132:135], v[68:71]
    ds_read_b64_tr_b16 a[150:151], v18 offset:34816
    s_waitcnt vmcnt(7)
    v_cmp_ne_u64 vcc, s[6:7], v[6:7]
    v_mfma_f32_16x16x32_bf16 v[68:71], v[100:103], v[120:123], v[68:71]
    ds_read_b64_tr_b16 a[154:155], v19 offset:34816
    v_bfe_u32 v28, v0, 2, 1
    v_mfma_f32_16x16x32_bf16 v[72:75], v[92:95], v[132:135], v[72:75]
    ds_read_b64_tr_b16 a[158:159], v20 offset:34816
    s_cbranch_vccnz Lslow_h
Lback_h:
    v_mfma_f32_16x16x32_bf16 v[72:75], v[100:103], v[124:127], v[72:75]
    ds_read2_b32 v[158:159], v38 offset0:178 offset1:179
    v_lshl_add_u32 v29, v28, 3, v29
    v_mfma_f32_16x16x32_bf16 v[76:79], v[96:99], v[132:135], v[76:79]
    ds_read_b128 v[188:191], v42 offset:3264
    v_add_u32 v14, s15, v29
    v_mfma_f32_16x16x32_bf16 v[76:79], v[100:103], v[128:131], v[76:79]
    ds_read2_b32 v[160:161], v39 offset0:48 offset1:49
    v_bfe_u32 v28, v0, 1, 3
    v_mfma_f32_16x16x32_bf16 v[80:83], v[100:103], v[132:135], v[80:83]
    ds_read2_b32 v[162:163], v39 offset0:50 offset1:51
    v_lshrrev_b32 v29, 5, v0
    v_mfma_f32_16x16x32_bf16 v[72:75], v[88:91], v[136:139], v[72:75]
    buffer_load_dwordx4 a[160:163], v1, s[68:71], s48 offen offset:0 sc1
    v_mfma_f32_16x16x32_bf16 v[72:75], v[104:107], v[120:123], v[72:75]
    ds_read_b128 v[192:195], v42 offset:2752
    v_xor_b32 v28, v28, v29
    v_mfma_f32_16x16x32_bf16 v[76:79], v[92:95], v[136:139], v[76:79]
    ds_read2_b32 v[164:165], v39 offset0:176 offset1:177
    ds_read2_b32 v[166:167], v39 offset0:178 offset1:179
    buffer_load_dwordx4 a[164:167], v1, s[68:71], s48 offen offset:2048 sc1
    ds_read_b128 v[196:199], v42 offset:2240
    ds_read2_b32 v[168:169], v40 offset0:48 offset1:49
    ds_read2_b32 v[170:171], v40 offset0:50 offset1:51
    s_add_u32 s48, s48, 4096
    buffer_load_dwordx4 a[168:171], v1, s[68:71], s48 offen offset:0 sc1
    ds_read_b64_tr_b16 a[112:113], v17 offset:0
    ds_read_b64_tr_b16 a[116:117], v18 offset:0
    ds_read_b64_tr_b16 a[120:121], v19 offset:0
    v_mfma_f32_16x16x32_bf16 v[76:79], v[104:107], v[124:127], v[76:79]
    ds_read_b64_tr_b16 a[124:125], v20 offset:0
    v_lshlrev_b32 v28, 4, v28
    v_mfma_f32_16x16x32_bf16 v[80:83], v[96:99], v[136:139], v[80:83]
    ds_read_b64_tr_b16 a[114:115], v17 offset:2048
    v_lshl_add_u32 v28, v10, 3, v28
    v_mfma_f32_16x16x32_bf16 v[80:83], v[104:107], v[128:131], v[80:83]
    ds_read_b64_tr_b16 a[118:119], v18 offset:2048
    v_bfe_u32 v29, v0, 4, 1
    v_mfma_f32_16x16x32_bf16 v[84:87], v[100:103], v[136:139], v[84:87]
    ds_read_b64_tr_b16 a[122:123], v19 offset:2048
    v_lshl_add_u32 v28, v29, 3, v28
    v_mfma_f32_16x16x32_bf16 v[84:87], v[104:107], v[132:135], v[84:87]
    ds_read_b64_tr_b16 a[126:127], v20 offset:2048
    v_add_u32 v24, s15, v28
    v_mfma_f32_16x16x32_bf16 v[76:79], v[88:91], v[140:143], v[76:79]
    buffer_load_dwordx4 a[172:175], v1, s[68:71], s48 offen offset:2048 sc1
    v_mfma_f32_16x16x32_bf16 v[76:79], v[108:111], v[120:123], v[76:79]
    ds_read_b128 v[200:203], v42 offset:1728
    s_add_u32 s48, s48, 4096
    v_mfma_f32_16x16x32_bf16 v[80:83], v[92:95], v[140:143], v[80:83]
    ds_read2_b32 v[172:173], v40 offset0:176 offset1:177
    v_xor_b32 v25, 32, v24
    v_mfma_f32_16x16x32_bf16 v[80:83], v[108:111], v[124:127], v[80:83]
    buffer_load_dwordx4 a[176:179], v1, s[68:71], s48 offen offset:0 sc1
    v_mfma_f32_16x16x32_bf16 v[84:87], v[96:99], v[140:143], v[84:87]
    ds_read2_b32 v[174:175], v40 offset0:178 offset1:179
    v_xor_b32 v26, 64, v24
    v_mfma_f32_16x16x32_bf16 v[84:87], v[108:111], v[128:131], v[84:87]
    ds_read_b128 v[204:207], v42 offset:1216
    v_xor_b32 v27, 96, v24
    v_mfma_f32_16x16x32_bf16 v[80:83], v[88:91], v[144:147], v[80:83]
    ds_read2_b32 v[176:177], v41 offset0:48 offset1:49
    s_mul_i32 s15, s3, 12288
    v_mfma_f32_16x16x32_bf16 v[80:83], v[112:115], v[120:123], v[80:83]
    ds_read2_b32 v[178:179], v41 offset0:50 offset1:51
    s_add_u32 s15, s15, 114688
    v_mfma_f32_16x16x32_bf16 v[84:87], v[92:95], v[144:147], v[84:87]
    buffer_load_dwordx4 a[180:183], v1, s[68:71], s48 offen offset:2048 sc1
    ds_read_b128 v[208:211], v42 offset:704
    ds_read2_b32 v[180:181], v41 offset0:176 offset1:177
    v_mfma_f32_16x16x32_bf16 v[84:87], v[112:115], v[124:127], v[84:87]
    ds_read2_b32 v[182:183], v41 offset0:178 offset1:179
    ds_read_b128 v[212:215], v42 offset:192
    s_add_u32 s48, s48, 4096
    buffer_load_dwordx4 a[184:187], v1, s[68:71], s48 offen offset:0 sc1
    buffer_load_dwordx4 a[188:191], v1, s[68:71], s49 offen offset:0 sc1
    s_waitcnt vmcnt(12)
    ds_read_b64_tr_b16 a[128:129], v17 offset:16384
    ds_read_b64_tr_b16 a[132:133], v18 offset:16384
    v_mfma_f32_16x16x32_bf16 v[84:87], v[88:91], v[148:151], v[84:87]
    ds_read_b64_tr_b16 a[136:137], v19 offset:16384
    v_add_u32 v21, s15, v1
    v_mfma_f32_16x16x32_bf16 v[84:87], v[116:119], v[120:123], v[84:87]
    ds_read_b64_tr_b16 a[140:141], v20 offset:16384
    ds_read_b64_tr_b16 a[130:131], v17 offset:18432
    ds_read_b64_tr_b16 a[134:135], v18 offset:18432
    ds_read_b64_tr_b16 a[138:139], v19 offset:18432
    ds_read_b64_tr_b16 a[142:143], v20 offset:18432
    buffer_load_dwordx4 a[192:195], v1, s[68:71], s49 offen offset:2048 sc1
    s_lshl_b32 s87, s29, 8
    s_add_u32 s87, s87, 393216
    s_add_u32 s49, s49, 4096
    buffer_load_dwordx4 a[196:199], v1, s[68:71], s49 offen offset:0 sc1
    s_waitcnt lgkmcnt(8)
    v_mfma_f32_16x16x32_bf16 v[56:59], v[152:155], v[184:187], v[56:59]
    v_mfma_f32_16x16x32_bf16 v[60:63], v[152:155], v[188:191], v[60:63]
    v_mfma_f32_16x16x32_bf16 v[60:63], v[156:159], v[184:187], v[60:63]
    buffer_load_dwordx4 a[200:203], v1, s[68:71], s49 offen offset:2048 sc1
    v_mfma_f32_16x16x32_bf16 v[64:67], v[156:159], v[188:191], v[64:67]
    s_add_u32 s49, s49, 4096
    v_mfma_f32_16x16x32_bf16 v[64:67], v[152:155], v[192:195], v[64:67]
    v_mfma_f32_16x16x32_bf16 v[64:67], v[160:163], v[184:187], v[64:67]
    v_mfma_f32_16x16x32_bf16 v[68:71], v[156:159], v[192:195], v[68:71]
    v_mfma_f32_16x16x32_bf16 v[68:71], v[160:163], v[188:191], v[68:71]
    buffer_load_dwordx4 a[204:207], v1, s[68:71], s49 offen offset:0 sc1
    v_mfma_f32_16x16x32_bf16 v[72:75], v[160:163], v[192:195], v[72:75]
    v_mfma_f32_16x16x32_bf16 v[68:71], v[152:155], v[196:199], v[68:71]
    v_mfma_f32_16x16x32_bf16 v[68:71], v[164:167], v[184:187], v[68:71]
    v_mfma_f32_16x16x32_bf16 v[72:75], v[156:159], v[196:199], v[72:75]
    buffer_load_dwordx4 a[208:211], v1, s[68:71], s49 offen offset:2048 sc1
    v_mfma_f32_16x16x32_bf16 v[72:75], v[164:167], v[188:191], v[72:75]
    s_add_u32 s49, s49, 4096
    v_mfma_f32_16x16x32_bf16 v[76:79], v[160:163], v[196:199], v[76:79]
    v_mfma_f32_16x16x32_bf16 v[76:79], v[164:167], v[192:195], v[76:79]
    v_mfma_f32_16x16x32_bf16 v[80:83], v[164:167], v[196:199], v[80:83]
    v_mfma_f32_16x16x32_bf16 v[72:75], v[152:155], v[200:203], v[72:75]
    buffer_load_dwordx4 a[212:215], v1, s[68:71], s49 offen offset:0 sc1
    v_mfma_f32_16x16x32_bf16 v[72:75], v[168:171], v[184:187], v[72:75]
    v_mfma_f32_16x16x32_bf16 v[76:79], v[156:159], v[200:203], v[76:79]
    v_mfma_f32_16x16x32_bf16 v[76:79], v[168:171], v[188:191], v[76:79]
    v_mfma_f32_16x16x32_bf16 v[80:83], v[160:163], v[200:203], v[80:83]
    buffer_load_dwordx4 a[216:219], v1, s[68:71], s50 offen offset:0 sc1
    v_mfma_f32_16x16x32_bf16 v[80:83], v[168:171], v[192:195], v[80:83]
    v_mfma_f32_16x16x32_bf16 v[84:87], v[164:167], v[200:203], v[84:87]
    v_mfma_f32_16x16x32_bf16 v[84:87], v[168:171], v[196:199], v[84:87]
    v_mfma_f32_16x16x32_bf16 v[76:79], v[152:155], v[204:207], v[76:79]
    v_mfma_f32_16x16x32_bf16 v[76:79], v[172:175], v[184:187], v[76:79]
    buffer_load_dwordx4 a[220:223], v1, s[68:71], s50 offen offset:2048 sc1
    v_mfma_f32_16x16x32_bf16 v[80:83], v[156:159], v[204:207], v[80:83]
    s_add_u32 s50, s50, 4096
    v_mfma_f32_16x16x32_bf16 v[80:83], v[172:175], v[188:191], v[80:83]
    v_mfma_f32_16x16x32_bf16 v[84:87], v[160:163], v[204:207], v[84:87]
    v_mfma_f32_16x16x32_bf16 v[84:87], v[172:175], v[192:195], v[84:87]
    buffer_load_dwordx4 a[224:227], v1, s[68:71], s50 offen offset:0 sc1
    v_mfma_f32_16x16x32_bf16 v[80:83], v[152:155], v[208:211], v[80:83]
    v_mfma_f32_16x16x32_bf16 v[80:83], v[176:179], v[184:187], v[80:83]
    s_waitcnt lgkmcnt(0)
    ds_write_b128 v52, v[56:59] offset:0
    v_mfma_f32_16x16x32_bf16 v[84:87], v[156:159], v[208:211], v[84:87]
    ds_write_b128 v52, v[60:63] offset:1280
    v_mfma_f32_16x16x32_bf16 v[84:87], v[176:179], v[188:191], v[84:87]
    ds_write_b128 v52, v[64:67] offset:2560
    v_mfma_f32_16x16x32_bf16 v[84:87], v[152:155], v[212:215], v[84:87]
    buffer_load_dwordx4 a[228:231], v1, s[68:71], s50 offen offset:2048 sc1
    v_mfma_f32_16x16x32_bf16 v[84:87], v[180:183], v[184:187], v[84:87]
    ds_write_b128 v52, v[68:71] offset:16384
    ds_write_b128 v52, v[72:75] offset:17664
    ds_write_b128 v52, v[76:79] offset:18944
    buffer_load_dwordx2 v[6:7], v8, s[68:71], s97 offen sc1
    ds_write_b128 v52, v[80:83] offset:32768
    s_nop 2
    ds_write_b128 v52, v[84:87] offset:34048
    buffer_load_dwordx4 v[40:43], v11, s[44:47], 0 offen
    s_add_u32 s50, s50, 4096
    s_waitcnt lgkmcnt(0)
    s_barrier
    ds_read_b128 v[56:59], v54 offset:0
    ds_read_b128 v[60:63], v54 offset:4096
    ds_read_b128 v[64:67], v54 offset:8192
    ds_read_b128 v[68:71], v54 offset:12288
    ds_read_b128 v[72:75], v55 offset:0
    ds_read_b128 v[76:79], v55 offset:4096
    ds_read_b128 v[80:83], v55 offset:8192
    ds_read_b128 v[84:87], v55 offset:12288
    buffer_load_dwordx4 v[44:47], v12, s[44:47], 0 offen
    s_waitcnt lgkmcnt(7)
    v_pk_add_f32 v[56:57], v[56:57], v[224:225]
    v_pk_add_f32 v[58:59], v[58:59], v[226:227]
    s_waitcnt lgkmcnt(6)
    v_pk_add_f32 v[56:57], v[56:57], v[60:61]
    v_pk_add_f32 v[58:59], v[58:59], v[62:63]
    v_cvt_pk_bf16_f32 v240, v56, v57
    v_cvt_pk_bf16_f32 v241, v58, v59
    s_waitcnt lgkmcnt(5)
    v_pk_add_f32 v[64:65], v[64:65], v[228:229]
    v_pk_add_f32 v[66:67], v[66:67], v[230:231]
    s_waitcnt lgkmcnt(4)
    v_pk_add_f32 v[64:65], v[64:65], v[68:69]
    v_pk_add_f32 v[66:67], v[66:67], v[70:71]
    v_cvt_pk_bf16_f32 v242, v64, v65
    v_cvt_pk_bf16_f32 v243, v66, v67
    buffer_store_dwordx4 v[240:243], v1, s[68:71], s28 offen offset:0 sc1
    s_waitcnt lgkmcnt(3)
    v_pk_add_f32 v[72:73], v[72:73], v[232:233]
    v_pk_add_f32 v[74:75], v[74:75], v[234:235]
    s_waitcnt lgkmcnt(2)
    v_pk_add_f32 v[72:73], v[72:73], v[76:77]
    v_pk_add_f32 v[74:75], v[74:75], v[78:79]
    v_cvt_pk_bf16_f32 v244, v72, v73
    v_cvt_pk_bf16_f32 v245, v74, v75
    s_waitcnt lgkmcnt(1)
    v_pk_add_f32 v[80:81], v[80:81], v[236:237]
    v_pk_add_f32 v[82:83], v[82:83], v[238:239]
    s_waitcnt lgkmcnt(0)
    v_pk_add_f32 v[80:81], v[80:81], v[84:85]
    v_pk_add_f32 v[82:83], v[82:83], v[86:87]
    v_cvt_pk_bf16_f32 v246, v80, v81
    v_cvt_pk_bf16_f32 v247, v82, v83
    buffer_store_dwordx4 v[244:247], v1, s[68:71], s28 offen offset:1024 sc1
    s_waitcnt vmcnt(22)
    v_mfma_f32_16x16x32_bf16 v[56:59], a[0:3], a[160:163], 0
    v_mfma_f32_16x16x32_bf16 v[60:63], a[4:7], a[160:163], 0
    v_mfma_f32_16x16x32_bf16 v[64:67], a[8:11], a[160:163], 0
    v_mfma_f32_16x16x32_bf16 v[68:71], a[12:15], a[160:163], 0
    s_waitcnt vmcnt(21)
    v_mfma_f32_16x16x32_bf16 v[56:59], a[16:19], a[164:167], v[56:59]
    v_mfma_f32_16x16x32_bf16 v[60:63], a[20:23], a[164:167], v[60:63]
    v_mfma_f32_16x16x32_bf16 v[64:67], a[24:27], a[164:167], v[64:67]
    v_mfma_f32_16x16x32_bf16 v[68:71], a[28:31], a[164:167], v[68:71]
    s_waitcnt vmcnt(20)
    v_mfma_f32_16x16x32_bf16 v[56:59], a[32:35], a[168:171], v[56:59]
    v_mfma_f32_16x16x32_bf16 v[60:63], a[36:39], a[168:171], v[60:63]
    v_mfma_f32_16x16x32_bf16 v[64:67], a[40:43], a[168:171], v[64:67]
    v_mfma_f32_16x16x32_bf16 v[68:71], a[44:47], a[168:171], v[68:71]
    s_waitcnt vmcnt(19)
    v_mfma_f32_16x16x32_bf16 v[56:59], a[48:51], a[172:175], v[56:59]
    buffer_load_dwordx4 a[232:235], v1, s[68:71], s50 offen offset:0 sc1
    v_mfma_f32_16x16x32_bf16 v[60:63], a[52:55], a[172:175], v[60:63]
    v_mfma_f32_16x16x32_bf16 v[64:67], a[56:59], a[172:175], v[64:67]
    ds_read_b64_tr_b16 a[160:161], v34 offset:16384
    v_mfma_f32_16x16x32_bf16 v[68:71], a[60:63], a[172:175], v[68:71]
    ds_read_b64_tr_b16 a[164:165], v35 offset:16384
    s_waitcnt vmcnt(19)
    v_mfma_f32_16x16x32_bf16 v[56:59], a[64:67], a[176:179], v[56:59]
    ds_read_b64_tr_b16 a[168:169], v36 offset:16384
    v_mfma_f32_16x16x32_bf16 v[60:63], a[68:71], a[176:179], v[60:63]
    ds_read_b64_tr_b16 a[172:173], v37 offset:16384
    v_mfma_f32_16x16x32_bf16 v[64:67], a[72:75], a[176:179], v[64:67]
    ds_read_b64_tr_b16 a[162:163], v34 offset:18432
    v_mfma_f32_16x16x32_bf16 v[68:71], a[76:79], a[176:179], v[68:71]
    ds_read_b64_tr_b16 a[166:167], v35 offset:18432
    s_waitcnt vmcnt(18)
    v_mfma_f32_16x16x32_bf16 v[56:59], a[80:83], a[180:183], v[56:59]
    ds_read_b64_tr_b16 a[170:171], v36 offset:18432
    ds_read_b64_tr_b16 a[174:175], v37 offset:18432
    buffer_load_dwordx4 a[236:239], v1, s[68:71], s50 offen offset:2048 sc1
    v_mfma_f32_16x16x32_bf16 v[60:63], a[84:87], a[180:183], v[60:63]
    s_add_u32 s50, s50, 4096
    v_mfma_f32_16x16x32_bf16 v[64:67], a[88:91], a[180:183], v[64:67]
    buffer_load_dwordx4 a[240:243], v1, s[68:71], s50 offen offset:0 sc1
    v_mfma_f32_16x16x32_bf16 v[68:71], a[92:95], a[180:183], v[68:71]
    s_waitcnt vmcnt(19)
    v_mfma_f32_16x16x32_bf16 v[56:59], a[96:99], a[184:187], v[56:59]
    s_add_u32 s48, s48, 4294955008
    v_mfma_f32_16x16x32_bf16 v[60:63], a[100:103], a[184:187], v[60:63]
    buffer_load_dwordx4 a[244:247], v1, s[68:71], s51 offen offset:0 sc1
    v_mfma_f32_16x16x32_bf16 v[64:67], a[104:107], a[184:187], v[64:67]
    v_mfma_f32_16x16x32_bf16 v[68:71], a[108:111], a[184:187], v[68:71]
    s_waitcnt vmcnt(19)
    v_mfma_f32_16x16x32_bf16 v[72:75], a[0:3], a[188:191], 0
    v_mfma_f32_16x16x32_bf16 v[76:79], a[4:7], a[188:191], 0
    buffer_load_dwordx4 a[248:251], v1, s[68:71], s51 offen offset:2048 sc1
    v_mfma_f32_16x16x32_bf16 v[80:83], a[8:11], a[188:191], 0
    ds_read_b64_tr_b16 a[176:177], v34 offset:49152
    s_add_u32 s51, s51, 4096
    v_mfma_f32_16x16x32_bf16 v[84:87], a[12:15], a[188:191], 0
    ds_read_b64_tr_b16 a[180:181], v35 offset:49152
    s_waitcnt vmcnt(19)
    v_mfma_f32_16x16x32_bf16 v[72:75], a[16:19], a[192:195], v[72:75]
    ds_read_b64_tr_b16 a[184:185], v36 offset:49152
    v_mfma_f32_16x16x32_bf16 v[76:79], a[20:23], a[192:195], v[76:79]
    ds_read_b64_tr_b16 a[188:189], v37 offset:49152
    v_mfma_f32_16x16x32_bf16 v[80:83], a[24:27], a[192:195], v[80:83]
    ds_read_b64_tr_b16 a[178:179], v34 offset:51200
    v_mfma_f32_16x16x32_bf16 v[84:87], a[28:31], a[192:195], v[84:87]
    ds_read_b64_tr_b16 a[182:183], v35 offset:51200
    s_waitcnt vmcnt(18)
    v_mfma_f32_16x16x32_bf16 v[72:75], a[32:35], a[196:199], v[72:75]
    ds_read_b64_tr_b16 a[186:187], v36 offset:51200
    v_mfma_f32_16x16x32_bf16 v[76:79], a[36:39], a[196:199], v[76:79]
    ds_read_b64_tr_b16 a[190:191], v37 offset:51200
    buffer_load_dwordx4 a[252:255], v1, s[68:71], s51 offen offset:0 sc1
    v_mfma_f32_16x16x32_bf16 v[80:83], a[40:43], a[196:199], v[80:83]
    buffer_load_dwordx4 v[120:123], v1, s[68:71], s51 offen offset:2048 sc1
    v_mfma_f32_16x16x32_bf16 v[84:87], a[44:47], a[196:199], v[84:87]
    s_add_u32 s51, s51, 4096
    s_waitcnt vmcnt(19)
    v_mfma_f32_16x16x32_bf16 v[72:75], a[48:51], a[200:203], v[72:75]
    s_add_u32 s49, s49, 4294955008
    v_mfma_f32_16x16x32_bf16 v[76:79], a[52:55], a[200:203], v[76:79]
    v_mfma_f32_16x16x32_bf16 v[80:83], a[56:59], a[200:203], v[80:83]
    buffer_load_dwordx4 v[124:127], v1, s[68:71], s51 offen offset:0 sc1
    v_mfma_f32_16x16x32_bf16 v[84:87], a[60:63], a[200:203], v[84:87]
    s_waitcnt vmcnt(19)
    v_mfma_f32_16x16x32_bf16 v[72:75], a[64:67], a[204:207], v[72:75]
    v_mfma_f32_16x16x32_bf16 v[76:79], a[68:71], a[204:207], v[76:79]
    v_mfma_f32_16x16x32_bf16 v[80:83], a[72:75], a[204:207], v[80:83]
    ds_read_b64_tr_b16 a[192:193], v34 offset:0
    v_mfma_f32_16x16x32_bf16 v[84:87], a[76:79], a[204:207], v[84:87]
    ds_read_b64_tr_b16 a[196:197], v35 offset:0
    s_waitcnt vmcnt(18)
    v_mfma_f32_16x16x32_bf16 v[72:75], a[80:83], a[208:211], v[72:75]
    ds_read_b64_tr_b16 a[200:201], v36 offset:0
    v_mfma_f32_16x16x32_bf16 v[76:79], a[84:87], a[208:211], v[76:79]
    ds_read_b64_tr_b16 a[204:205], v37 offset:0
    v_mfma_f32_16x16x32_bf16 v[80:83], a[88:91], a[208:211], v[80:83]
    ds_read_b64_tr_b16 a[194:195], v34 offset:2048
    ds_read_b64_tr_b16 a[198:199], v35 offset:2048
    ds_read_b64_tr_b16 a[202:203], v36 offset:2048
    ds_read_b64_tr_b16 a[206:207], v37 offset:2048
    s_waitcnt vmcnt(8)
    buffer_store_dwordx2 v[4:5], v3, s[68:71], s42 offen sc1
    v_mfma_f32_16x16x32_bf16 v[84:87], a[92:95], a[208:211], v[84:87]
    buffer_load_dwordx4 v[128:131], v1, s[68:71], s51 offen offset:2048 sc1
    v_mfma_f32_16x16x32_bf16 v[72:75], a[96:99], a[212:215], v[72:75]
    s_add_u32 s51, s51, 4096
    v_mfma_f32_16x16x32_bf16 v[76:79], a[100:103], a[212:215], v[76:79]
    buffer_load_dwordx4 v[132:135], v1, s[68:71], s51 offen offset:0 sc1
    v_mfma_f32_16x16x32_bf16 v[80:83], a[104:107], a[212:215], v[80:83]
    v_mfma_f32_16x16x32_bf16 v[84:87], a[108:111], a[212:215], v[84:87]
    v_mfma_f32_16x16x32_bf16 v[88:91], a[0:3], a[216:219], 0
    buffer_load_dwordx4 v[30:33], v10, s[68:71], s87 offen sc1
    v_mfma_f32_16x16x32_bf16 v[92:95], a[4:7], a[216:219], 0
    global_load_dwordx2 v[48:49], v16, s[36:37] offset:0
    v_mfma_f32_16x16x32_bf16 v[96:99], a[8:11], a[216:219], 0
    global_load_dwordx2 v[50:51], v16, s[36:37] offset:32
    v_mfma_f32_16x16x32_bf16 v[100:103], a[12:15], a[216:219], 0
    global_load_dwordx2 v[52:53], v16, s[36:37] offset:64
    v_mfma_f32_16x16x32_bf16 v[88:91], a[16:19], a[220:223], v[88:91]
    global_load_dwordx2 v[54:55], v16, s[36:37] offset:96
    v_mfma_f32_16x16x32_bf16 v[92:95], a[20:23], a[220:223], v[92:95]
    v_cmp_ne_u64 vcc, s[6:7], v[6:7]
    s_add_u32 s50, s50, 4294955008
    v_mfma_f32_16x16x32_bf16 v[96:99], a[24:27], a[220:223], v[96:99]
    ds_read_b64_tr_b16 a[208:209], v34 offset:32768
    v_mfma_f32_16x16x32_bf16 v[100:103], a[28:31], a[220:223], v[100:103]
    ds_read_b64_tr_b16 a[212:213], v35 offset:32768
    s_cbranch_vccnz Lslow_h2
Lback_h2:
    v_mfma_f32_16x16x32_bf16 v[88:91], a[32:35], a[224:227], v[88:91]
    ds_read_b64_tr_b16 a[216:217], v36 offset:32768
    ds_read_b64_tr_b16 a[220:221], v37 offset:32768
    ds_read_b64_tr_b16 a[210:211], v34 offset:34816
    ds_read_b64_tr_b16 a[214:215], v35 offset:34816
    ds_read_b64_tr_b16 a[218:219], v36 offset:34816
    ds_read_b64_tr_b16 a[222:223], v37 offset:34816
    buffer_load_dwordx4 v[136:139], v1, s[68:71], s48 offen offset:1024 sc1
    v_mfma_f32_16x16x32_bf16 v[92:95], a[36:39], a[224:227], v[92:95]
    buffer_load_dwordx4 v[140:143], v1, s[68:71], s48 offen offset:3072 sc1
    v_mfma_f32_16x16x32_bf16 v[96:99], a[40:43], a[224:227], v[96:99]
    s_add_u32 s48, s48, 4096
    v_mfma_f32_16x16x32_bf16 v[100:103], a[44:47], a[224:227], v[100:103]
    buffer_load_dwordx4 v[144:147], v1, s[68:71], s48 offen offset:1024 sc1
    v_mfma_f32_16x16x32_bf16 v[88:91], a[48:51], a[228:231], v[88:91]
    buffer_load_dwordx4 v[148:151], v1, s[68:71], s48 offen offset:3072 sc1
    v_mfma_f32_16x16x32_bf16 v[92:95], a[52:55], a[228:231], v[92:95]
    s_add_u32 s48, s48, 4096
    v_mfma_f32_16x16x32_bf16 v[96:99], a[56:59], a[228:231], v[96:99]
    buffer_load_dwordx4 v[152:155], v1, s[68:71], s48 offen offset:1024 sc1
    v_mfma_f32_16x16x32_bf16 v[100:103], a[60:63], a[228:231], v[100:103]
    buffer_load_dwordx4 v[156:159], v1, s[68:71], s48 offen offset:3072 sc1
    s_waitcnt vmcnt(21)
    v_mfma_f32_16x16x32_bf16 v[88:91], a[64:67], a[232:235], v[88:91]
    s_add_u32 s48, s48, 4096
    v_mfma_f32_16x16x32_bf16 v[92:95], a[68:71], a[232:235], v[92:95]
    buffer_load_dwordx4 v[160:163], v1, s[68:71], s48 offen offset:1024 sc1
    v_mfma_f32_16x16x32_bf16 v[96:99], a[72:75], a[232:235], v[96:99]
    v_mfma_f32_16x16x32_bf16 v[100:103], a[76:79], a[232:235], v[100:103]
    s_waitcnt vmcnt(21)
    v_mfma_f32_16x16x32_bf16 v[88:91], a[80:83], a[236:239], v[88:91]
    buffer_load_dwordx4 v[164:167], v1, s[68:71], s49 offen offset:1024 sc1
    v_mfma_f32_16x16x32_bf16 v[92:95], a[84:87], a[236:239], v[92:95]
    v_mfma_f32_16x16x32_bf16 v[96:99], a[88:91], a[236:239], v[96:99]
    v_mfma_f32_16x16x32_bf16 v[100:103], a[92:95], a[236:239], v[100:103]
    s_waitcnt vmcnt(21)
    v_mfma_f32_16x16x32_bf16 v[88:91], a[96:99], a[240:243], v[88:91]
    buffer_load_dwordx4 v[168:171], v1, s[68:71], s49 offen offset:3072 sc1
    v_mfma_f32_16x16x32_bf16 v[92:95], a[100:103], a[240:243], v[92:95]
    s_add_u32 s49, s49, 4096
    v_mfma_f32_16x16x32_bf16 v[96:99], a[104:107], a[240:243], v[96:99]
    v_mfma_f32_16x16x32_bf16 v[100:103], a[108:111], a[240:243], v[100:103]
    s_waitcnt vmcnt(21)
    v_mfma_f32_16x16x32_bf16 v[104:107], a[0:3], a[244:247], 0
    v_mfma_f32_16x16x32_bf16 v[108:111], a[4:7], a[244:247], 0
    buffer_load_dwordx4 v[172:175], v1, s[68:71], s49 offen offset:1024 sc1
    v_mfma_f32_16x16x32_bf16 v[112:115], a[8:11], a[244:247], 0
    v_mfma_f32_16x16x32_bf16 v[116:119], a[12:15], a[244:247], 0
    s_waitcnt vmcnt(21)
    v_mfma_f32_16x16x32_bf16 v[104:107], a[16:19], a[248:251], v[104:107]
    v_mfma_f32_16x16x32_bf16 v[108:111], a[20:23], a[248:251], v[108:111]
    buffer_load_dwordx4 v[176:179], v1, s[68:71], s49 offen offset:3072 sc1
    v_mfma_f32_16x16x32_bf16 v[112:115], a[24:27], a[248:251], v[112:115]
    s_add_u32 s49, s49, 4096
    v_mfma_f32_16x16x32_bf16 v[116:119], a[28:31], a[248:251], v[116:119]
    buffer_load_dwordx4 v[180:183], v1, s[68:71], s49 offen offset:1024 sc1
    s_waitcnt vmcnt(22)
    v_mfma_f32_16x16x32_bf16 v[104:107], a[32:35], a[252:255], v[104:107]
    buffer_load_dwordx4 v[184:187], v1, s[68:71], s49 offen offset:3072 sc1
    v_mfma_f32_16x16x32_bf16 v[108:111], a[36:39], a[252:255], v[108:111]
    s_waitcnt vmcnt(13) lgkmcnt(15)
    ds_write_b128 v13, v[40:43]
    s_add_u32 s49, s49, 4096
    buffer_load_dwordx4 v[188:191], v1, s[68:71], s49 offen offset:1024 sc1
    v_mfma_f32_16x16x32_bf16 v[112:115], a[40:43], a[252:255], v[112:115]
    buffer_load_dwordx4 v[192:195], v1, s[68:71], s50 offen offset:1024 sc1
    v_mfma_f32_16x16x32_bf16 v[116:119], a[44:47], a[252:255], v[116:119]
    s_add_u32 s51, s51, 4294955008
    v_mfma_f32_16x16x32_bf16 v[104:107], a[48:51], v[120:123], v[104:107]
    ds_write_b128 v13, v[44:47] offset:1024
    v_mfma_f32_16x16x32_bf16 v[108:111], a[52:55], v[120:123], v[108:111]
    buffer_load_dwordx4 v[196:199], v1, s[68:71], s50 offen offset:3072 sc1
    v_mfma_f32_16x16x32_bf16 v[112:115], a[56:59], v[120:123], v[112:115]
    s_add_u32 s50, s50, 4096
    v_mfma_f32_16x16x32_bf16 v[116:119], a[60:63], v[120:123], v[116:119]
    ds_read_b64 v[40:41], v24
    v_mfma_f32_16x16x32_bf16 v[104:107], a[64:67], v[124:127], v[104:107]
    v_mfma_f32_16x16x32_bf16 v[108:111], a[68:71], v[124:127], v[108:111]
    buffer_load_dwordx4 v[200:203], v1, s[68:71], s50 offen offset:1024 sc1
    v_mfma_f32_16x16x32_bf16 v[112:115], a[72:75], v[124:127], v[112:115]
    s_add_u32 s15, s3, 1
    s_and_b32 s15, s15, 3
    v_mfma_f32_16x16x32_bf16 v[116:119], a[76:79], v[124:127], v[116:119]
    ds_read_b64 v[42:43], v25
    s_mul_i32 s15, s15, 12288
    v_mfma_f32_16x16x32_bf16 v[104:107], a[80:83], v[128:131], v[104:107]
    s_add_u32 s15, s15, 114688
    v_add_u32 v22, s15, v1
    v_mfma_f32_16x16x32_bf16 v[108:111], a[84:87], v[128:131], v[108:111]
    v_mfma_f32_16x16x32_bf16 v[112:115], a[88:91], v[128:131], v[112:115]
    buffer_load_dwordx4 v[204:207], v1, s[68:71], s50 offen offset:3072 sc1
    v_mfma_f32_16x16x32_bf16 v[116:119], a[92:95], v[128:131], v[116:119]
    ds_read_b64 v[44:45], v26
    s_add_u32 s50, s50, 4096
    v_mfma_f32_16x16x32_bf16 v[104:107], a[96:99], v[132:135], v[104:107]
    s_waitcnt lgkmcnt(2)
    v_lshlrev_b32 v224, 16, v40
    v_and_b32 v225, 0xffff0000, v40
    v_mfma_f32_16x16x32_bf16 v[108:111], a[100:103], v[132:135], v[108:111]
    v_lshlrev_b32 v226, 16, v41
    v_and_b32 v227, 0xffff0000, v41
    v_mfma_f32_16x16x32_bf16 v[112:115], a[104:107], v[132:135], v[112:115]
    ds_read_b64 v[46:47], v27
    v_mfma_f32_16x16x32_bf16 v[116:119], a[108:111], v[132:135], v[116:119]
    v_cmp_ne_u64 vcc, s[6:7], v[32:33]
    s_waitcnt vmcnt(17)
    v_mfma_f32_16x16x32_bf16 v[56:59], a[112:115], v[136:139], v[56:59]
    s_waitcnt lgkmcnt(2)
    v_lshlrev_b32 v228, 16, v42
    v_and_b32 v229, 0xffff0000, v42
    v_mfma_f32_16x16x32_bf16 v[60:63], a[116:119], v[136:139], v[60:63]
    s_cbranch_vccnz Lslow_est
Lback_est:
    v_lshlrev_b32 v230, 16, v43
    v_mfma_f32_16x16x32_bf16 v[64:67], a[120:123], v[136:139], v[64:67]
    buffer_load_dwordx2 v[6:7], v23, s[68:71], 0 offen sc1
    v_mfma_f32_16x16x32_bf16 v[68:71], a[124:127], v[136:139], v[68:71]
    v_lshlrev_b32 v208, 16, v48
    v_add_f32 v208, v208, v224
    s_waitcnt vmcnt(17)
    v_mfma_f32_16x16x32_bf16 v[56:59], a[128:131], v[140:143], v[56:59]
    buffer_load_dwordx4 v[248:251], v1, s[68:71], s50 offen offset:1024 sc1
    v_mfma_f32_16x16x32_bf16 v[60:63], a[132:135], v[140:143], v[60:63]
    v_sub_f32 v224, v224, v30
    v_mul_f32 v224, v224, v31
    v_mfma_f32_16x16x32_bf16 v[64:67], a[136:139], v[140:143], v[64:67]
    v_and_b32 v209, 0xffff0000, v48
    v_add_f32 v209, v209, v225
    v_mfma_f32_16x16x32_bf16 v[68:71], a[140:143], v[140:143], v[68:71]
    v_sub_f32 v225, v225, v30
    v_mul_f32 v225, v225, v31
    s_waitcnt vmcnt(17)
    v_mfma_f32_16x16x32_bf16 v[56:59], a[144:147], v[144:147], v[56:59]
    buffer_load_dwordx4 v[252:255], v1, s[68:71], s50 offen offset:3072 sc1
    v_mfma_f32_16x16x32_bf16 v[60:63], a[148:151], v[144:147], v[60:63]
    v_lshlrev_b32 v210, 16, v49
    v_add_f32 v210, v210, v226
    v_mfma_f32_16x16x32_bf16 v[64:67], a[152:155], v[144:147], v[64:67]
    v_sub_f32 v226, v226, v30
    v_mul_f32 v226, v226, v31
    v_mfma_f32_16x16x32_bf16 v[68:71], a[156:159], v[144:147], v[68:71]
    v_and_b32 v211, 0xffff0000, v49
    v_add_f32 v211, v211, v227
    s_waitcnt vmcnt(17)
    v_mfma_f32_16x16x32_bf16 v[56:59], a[160:163], v[148:151], v[56:59]
    v_sub_f32 v227, v227, v30
    v_mul_f32 v227, v227, v31
    v_mfma_f32_16x16x32_bf16 v[60:63], a[164:167], v[148:151], v[60:63]
    s_add_u32 s50, s50, 4096
    v_and_b32 v231, 0xffff0000, v43
    v_mfma_f32_16x16x32_bf16 v[64:67], a[168:171], v[148:151], v[64:67]
    buffer_load_dwordx4 a[224:227], v1, s[68:71], s50 offen offset:1024 sc1
    v_mfma_f32_16x16x32_bf16 v[68:71], a[172:175], v[148:151], v[68:71]
    v_lshlrev_b32 v212, 16, v50
    v_add_f32 v212, v212, v228
    s_waitcnt vmcnt(17)
    v_mfma_f32_16x16x32_bf16 v[56:59], a[176:179], v[152:155], v[56:59]
    v_sub_f32 v228, v228, v30
    v_mul_f32 v228, v228, v31
    v_mfma_f32_16x16x32_bf16 v[60:63], a[180:183], v[152:155], v[60:63]
    buffer_load_dwordx4 a[228:231], v1, s[68:71], s51 offen offset:1024 sc1
    v_mfma_f32_16x16x32_bf16 v[64:67], a[184:187], v[152:155], v[64:67]
    v_and_b32 v213, 0xffff0000, v50
    v_add_f32 v213, v213, v229
    v_mfma_f32_16x16x32_bf16 v[68:71], a[188:191], v[152:155], v[68:71]
    v_sub_f32 v229, v229, v30
    v_mul_f32 v229, v229, v31
    s_waitcnt vmcnt(17)
    v_mfma_f32_16x16x32_bf16 v[56:59], a[192:195], v[156:159], v[56:59]
    s_waitcnt lgkmcnt(1)
    v_lshlrev_b32 v232, 16, v44
    v_and_b32 v233, 0xffff0000, v44
    v_mfma_f32_16x16x32_bf16 v[60:63], a[196:199], v[156:159], v[60:63]
    v_lshlrev_b32 v234, 16, v45
    v_and_b32 v235, 0xffff0000, v45
    v_mfma_f32_16x16x32_bf16 v[64:67], a[200:203], v[156:159], v[64:67]
    buffer_load_dwordx4 a[232:235], v1, s[68:71], s51 offen offset:3072 sc1
    v_mfma_f32_16x16x32_bf16 v[68:71], a[204:207], v[156:159], v[68:71]
    v_lshlrev_b32 v214, 16, v51
    v_add_f32 v214, v214, v230
    s_waitcnt vmcnt(17)
    v_mfma_f32_16x16x32_bf16 v[56:59], a[208:211], v[160:163], v[56:59]
    v_sub_f32 v230, v230, v30
    v_mul_f32 v230, v230, v31
    v_mfma_f32_16x16x32_bf16 v[60:63], a[212:215], v[160:163], v[60:63]
    v_and_b32 v215, 0xffff0000, v51
    v_add_f32 v215, v215, v231
    v_mfma_f32_16x16x32_bf16 v[64:67], a[216:219], v[160:163], v[64:67]
    v_sub_f32 v231, v231, v30
    s_add_u32 s51, s51, 4096
    v_mfma_f32_16x16x32_bf16 v[68:71], a[220:223], v[160:163], v[68:71]
    buffer_load_dwordx4 a[236:239], v1, s[68:71], s51 offen offset:1024 sc1
    s_waitcnt vmcnt(17)
    v_mfma_f32_16x16x32_bf16 v[72:75], a[112:115], v[164:167], v[72:75]
    ds_write_b128 v22, v[56:59] offset:0
    v_mfma_f32_16x16x32_bf16 v[76:79], a[116:119], v[164:167], v[76:79]
    ds_write_b128 v22, v[60:63] offset:1024
    v_mfma_f32_16x16x32_bf16 v[80:83], a[120:123], v[164:167], v[80:83]
    buffer_load_dwordx4 a[240:243], v1, s[68:71], s51 offen offset:3072 sc1
    v_mfma_f32_16x16x32_bf16 v[84:87], a[124:127], v[164:167], v[84:87]
    ds_write_b128 v22, v[64:67] offset:2048
    s_waitcnt vmcnt(17)
    v_mfma_f32_16x16x32_bf16 v[72:75], a[128:131], v[168:171], v[72:75]
    ds_write_b128 v22, v[68:71] offset:3072
    v_mfma_f32_16x16x32_bf16 v[76:79], a[132:135], v[168:171], v[76:79]
    s_add_u32 s51, s51, 4096
    v_mul_f32 v231, v231, v31
    v_mfma_f32_16x16x32_bf16 v[80:83], a[136:139], v[168:171], v[80:83]
    buffer_load_dwordx4 a[244:247], v1, s[68:71], s51 offen offset:1024 sc1
    v_mfma_f32_16x16x32_bf16 v[84:87], a[140:143], v[168:171], v[84:87]
    buffer_load_dwordx4 a[248:251], v1, s[68:71], s51 offen offset:3072 sc1
    s_waitcnt vmcnt(18)
    v_mfma_f32_16x16x32_bf16 v[72:75], a[144:147], v[172:175], v[72:75]
    v_lshlrev_b32 v216, 16, v52
    v_add_f32 v216, v216, v232
    v_mfma_f32_16x16x32_bf16 v[76:79], a[148:151], v[172:175], v[76:79]
    v_sub_f32 v232, v232, v30
    v_mul_f32 v232, v232, v31
    v_mfma_f32_16x16x32_bf16 v[80:83], a[152:155], v[172:175], v[80:83]
    v_and_b32 v217, 0xffff0000, v52
    v_add_f32 v217, v217, v233
    v_mfma_f32_16x16x32_bf16 v[84:87], a[156:159], v[172:175], v[84:87]
    v_sub_f32 v233, v233, v30
    v_mul_f32 v233, v233, v31
    s_waitcnt vmcnt(17)
    v_mfma_f32_16x16x32_bf16 v[72:75], a[160:163], v[176:179], v[72:75]
    v_lshlrev_b32 v218, 16, v53
    v_add_f32 v218, v218, v234
    v_mfma_f32_16x16x32_bf16 v[76:79], a[164:167], v[176:179], v[76:79]
    v_sub_f32 v234, v234, v30
    s_add_u32 s51, s51, 4096
    v_mfma_f32_16x16x32_bf16 v[80:83], a[168:171], v[176:179], v[80:83]
    buffer_load_dwordx4 a[252:255], v1, s[68:71], s51 offen offset:1024 sc1
    v_mfma_f32_16x16x32_bf16 v[84:87], a[172:175], v[176:179], v[84:87]
    v_mul_f32 v234, v234, v31
    s_waitcnt vmcnt(10)
    v_cmp_ne_u64 vcc, s[6:7], v[6:7]
    v_mfma_f32_16x16x32_bf16 v[72:75], a[176:179], v[180:183], v[72:75]
    v_and_b32 v219, 0xffff0000, v53
    v_add_f32 v219, v219, v235
    v_mfma_f32_16x16x32_bf16 v[76:79], a[180:183], v[180:183], v[76:79]
    s_nop 0
    s_cbranch_vccnz Lslow_y
Lback_y:
    v_sub_f32 v235, v235, v30
    v_mfma_f32_16x16x32_bf16 v[80:83], a[184:187], v[180:183], v[80:83]
    buffer_load_dwordx4 v[240:243], v15, s[68:71], s78 offen sc1
    v_mfma_f32_16x16x32_bf16 v[84:87], a[188:191], v[180:183], v[84:87]
    v_mul_f32 v235, v235, v31
    s_waitcnt lgkmcnt(4)
    v_lshlrev_b32 v236, 16, v46
    v_mfma_f32_16x16x32_bf16 v[72:75], a[192:195], v[184:187], v[72:75]
    buffer_load_dwordx4 v[244:247], v15, s[68:71], s79 offen sc1
    v_mfma_f32_16x16x32_bf16 v[76:79], a[196:199], v[184:187], v[76:79]
    v_lshlrev_b32 v220, 16, v54
    v_add_f32 v220, v220, v236
    v_mfma_f32_16x16x32_bf16 v[80:83], a[200:203], v[184:187], v[80:83]
    v_sub_f32 v236, v236, v30
    v_mul_f32 v236, v236, v31
    v_mfma_f32_16x16x32_bf16 v[84:87], a[204:207], v[184:187], v[84:87]
    v_and_b32 v237, 0xffff0000, v46
    v_and_b32 v221, 0xffff0000, v54
    v_mfma_f32_16x16x32_bf16 v[72:75], a[208:211], v[188:191], v[72:75]
    v_add_f32 v221, v221, v237
    v_sub_f32 v237, v237, v30
    v_mfma_f32_16x16x32_bf16 v[76:79], a[212:215], v[188:191], v[76:79]
    v_mul_f32 v237, v237, v31
    v_lshlrev_b32 v238, 16, v47
    v_mfma_f32_16x16x32_bf16 v[80:83], a[216:219], v[188:191], v[80:83]
    v_lshlrev_b32 v222, 16, v55
    v_add_f32 v222, v222, v238
    v_mfma_f32_16x16x32_bf16 v[84:87], a[220:223], v[188:191], v[84:87]
    v_sub_f32 v238, v238, v30
    v_mul_f32 v238, v238, v31
    v_mfma_f32_16x16x32_bf16 v[88:91], a[112:115], v[192:195], v[88:91]
    v_and_b32 v239, 0xffff0000, v47
    v_and_b32 v223, 0xffff0000, v55
    v_mfma_f32_16x16x32_bf16 v[92:95], a[116:119], v[192:195], v[92:95]
    v_add_f32 v223, v223, v239
    v_sub_f32 v239, v239, v30
    v_mfma_f32_16x16x32_bf16 v[96:99], a[120:123], v[192:195], v[96:99]
    v_mul_f32 v239, v239, v31
    s_add_u32 s15, s3, 2
    v_mfma_f32_16x16x32_bf16 v[100:103], a[124:127], v[192:195], v[100:103]
    s_and_b32 s15, s15, 3
    s_mul_i32 s15, s15, 12288
    v_mfma_f32_16x16x32_bf16 v[88:91], a[128:131], v[196:199], v[88:91]
    s_add_u32 s15, s15, 118784
    v_add_u32 v22, s15, v1
    v_mfma_f32_16x16x32_bf16 v[92:95], a[132:135], v[196:199], v[92:95]
    s_add_u32 s15, s3, 3
    s_and_b32 s15, s15, 3
    v_mfma_f32_16x16x32_bf16 v[96:99], a[136:139], v[196:199], v[96:99]
    s_mul_i32 s15, s15, 12288
    s_add_u32 s15, s15, 122880
    v_mfma_f32_16x16x32_bf16 v[100:103], a[140:143], v[196:199], v[100:103]
    v_mfma_f32_16x16x32_bf16 v[88:91], a[144:147], v[200:203], v[88:91]
    v_mfma_f32_16x16x32_bf16 v[92:95], a[148:151], v[200:203], v[92:95]
    v_mfma_f32_16x16x32_bf16 v[96:99], a[152:155], v[200:203], v[96:99]
    v_mfma_f32_16x16x32_bf16 v[100:103], a[156:159], v[200:203], v[100:103]
    v_mfma_f32_16x16x32_bf16 v[88:91], a[160:163], v[204:207], v[88:91]
    v_mfma_f32_16x16x32_bf16 v[92:95], a[164:167], v[204:207], v[92:95]
    v_mfma_f32_16x16x32_bf16 v[96:99], a[168:171], v[204:207], v[96:99]
    ds_write_b128 v22, v[72:75] offset:0
    v_mfma_f32_16x16x32_bf16 v[100:103], a[172:175], v[204:207], v[100:103]
    s_waitcnt vmcnt(11)
    v_mfma_f32_16x16x32_bf16 v[88:91], a[176:179], v[248:251], v[88:91]
    v_mfma_f32_16x16x32_bf16 v[92:95], a[180:183], v[248:251], v[92:95]
    ds_write_b128 v22, v[76:79] offset:1024
    v_mfma_f32_16x16x32_bf16 v[96:99], a[184:187], v[248:251], v[96:99]
    v_mfma_f32_16x16x32_bf16 v[100:103], a[188:191], v[248:251], v[100:103]
    s_waitcnt vmcnt(10)
    v_mfma_f32_16x16x32_bf16 v[88:91], a[192:195], v[252:255], v[88:91]
    ds_write_b128 v22, v[80:83] offset:2048
    v_mfma_f32_16x16x32_bf16 v[92:95], a[196:199], v[252:255], v[92:95]
    v_mfma_f32_16x16x32_bf16 v[96:99], a[200:203], v[252:255], v[96:99]
    v_mfma_f32_16x16x32_bf16 v[100:103], a[204:207], v[252:255], v[100:103]
    ds_write_b128 v22, v[84:87] offset:3072
    s_waitcnt vmcnt(9)
    v_mfma_f32_16x16x32_bf16 v[88:91], a[208:211], a[224:227], v[88:91]
    v_add_u32 v22, s15, v1
    v_mfma_f32_16x16x32_bf16 v[92:95], a[212:215], a[224:227], v[92:95]
    v_mfma_f32_16x16x32_bf16 v[96:99], a[216:219], a[224:227], v[96:99]
    v_mfma_f32_16x16x32_bf16 v[100:103], a[220:223], a[224:227], v[100:103]
    s_waitcnt vmcnt(8)
    v_mfma_f32_16x16x32_bf16 v[104:107], a[112:115], a[228:231], v[104:107]
    v_mfma_f32_16x16x32_bf16 v[108:111], a[116:119], a[228:231], v[108:111]
    s_nop 0
    ds_write_b128 v22, v[88:91] offset:0
    v_mfma_f32_16x16x32_bf16 v[112:115], a[120:123], a[228:231], v[112:115]
    ds_write_b128 v22, v[92:95] offset:1024
    v_mfma_f32_16x16x32_bf16 v[116:119], a[124:127], a[228:231], v[116:119]
    ds_write_b128 v22, v[96:99] offset:2048
    s_waitcnt vmcnt(7)
    v_mfma_f32_16x16x32_bf16 v[104:107], a[128:131], a[232:235], v[104:107]
    ds_write_b128 v22, v[100:103] offset:3072
    v_mfma_f32_16x16x32_bf16 v[108:111], a[132:135], a[232:235], v[108:111]
    v_mfma_f32_16x16x32_bf16 v[112:115], a[136:139], a[232:235], v[112:115]
    v_mfma_f32_16x16x32_bf16 v[116:119], a[140:143], a[232:235], v[116:119]
    s_waitcnt vmcnt(6)
    v_mfma_f32_16x16x32_bf16 v[104:107], a[144:147], a[236:239], v[104:107]
    s_waitcnt lgkmcnt(0)
    s_barrier
    ds_read_b128 v[56:59], v21 offset:0
    v_mfma_f32_16x16x32_bf16 v[108:111], a[148:151], a[236:239], v[108:111]
    ds_read_b128 v[60:63], v21 offset:1024
    v_mfma_f32_16x16x32_bf16 v[112:115], a[152:155], a[236:239], v[112:115]
    ds_read_b128 v[64:67], v21 offset:2048
    v_mfma_f32_16x16x32_bf16 v[116:119], a[156:159], a[236:239], v[116:119]
    ds_read_b128 v[68:71], v21 offset:3072
    s_waitcnt vmcnt(5)
    v_mfma_f32_16x16x32_bf16 v[104:107], a[160:163], a[240:243], v[104:107]
    ds_read_b128 v[72:75], v21 offset:4096
    v_mfma_f32_16x16x32_bf16 v[108:111], a[164:167], a[240:243], v[108:111]
    ds_read_b128 v[76:79], v21 offset:5120
    v_mfma_f32_16x16x32_bf16 v[112:115], a[168:171], a[240:243], v[112:115]
    ds_read_b128 v[80:83], v21 offset:6144
    v_mfma_f32_16x16x32_bf16 v[116:119], a[172:175], a[240:243], v[116:119]
    ds_read_b128 v[84:87], v21 offset:7168
    s_waitcnt vmcnt(4)
    v_mfma_f32_16x16x32_bf16 v[104:107], a[176:179], a[244:247], v[104:107]
    ds_read_b128 v[88:91], v21 offset:8192
    v_mfma_f32_16x16x32_bf16 v[108:111], a[180:183], a[244:247], v[108:111]
    ds_read_b128 v[92:95], v21 offset:9216
    s_waitcnt lgkmcnt(9)
    v_add_f32 v208, v208, v56
    v_mfma_f32_16x16x32_bf16 v[112:115], a[184:187], a[244:247], v[112:115]
    ds_read_b128 v[96:99], v21 offset:10240
    v_add_f32 v209, v209, v57
    v_mfma_f32_16x16x32_bf16 v[116:119], a[188:191], a[244:247], v[116:119]
    ds_read_b128 v[100:103], v21 offset:11264
    v_add_f32 v210, v210, v58
    s_waitcnt vmcnt(3)
    v_mfma_f32_16x16x32_bf16 v[104:107], a[192:195], a[248:251], v[104:107]
    v_add_f32 v211, v211, v59
    s_waitcnt lgkmcnt(10)
    v_add_f32 v212, v212, v60
    v_mfma_f32_16x16x32_bf16 v[108:111], a[196:199], a[248:251], v[108:111]
    v_add_f32 v213, v213, v61
    v_add_f32 v214, v214, v62
    v_mfma_f32_16x16x32_bf16 v[112:115], a[200:203], a[248:251], v[112:115]
    v_add_f32 v215, v215, v63
    s_waitcnt lgkmcnt(9)
    v_add_f32 v216, v216, v64
    v_mfma_f32_16x16x32_bf16 v[116:119], a[204:207], a[248:251], v[116:119]
    v_add_f32 v217, v217, v65
    v_add_f32 v218, v218, v66
    s_waitcnt vmcnt(2)
    v_mfma_f32_16x16x32_bf16 v[104:107], a[208:211], a[252:255], v[104:107]
    s_waitcnt vmcnt(0)
    ds_write_b128 v13, v[240:243] offset:2048
    v_mfma_f32_16x16x32_bf16 v[108:111], a[212:215], a[252:255], v[108:111]
    ds_write_b128 v13, v[244:247] offset:3072
    v_mfma_f32_16x16x32_bf16 v[112:115], a[216:219], a[252:255], v[112:115]
    ds_read_b64_tr_b16 v[48:49], v14 offset:2048
    v_add_f32 v219, v219, v67
    v_mfma_f32_16x16x32_bf16 v[116:119], a[220:223], a[252:255], v[116:119]
    ds_read_b64_tr_b16 v[50:51], v14 offset:2560
    s_waitcnt lgkmcnt(12)
    v_add_f32 v220, v220, v68
    v_add_f32 v221, v221, v69
    v_add_f32 v222, v222, v70
    v_add_f32 v223, v223, v71
    ds_read_b64_tr_b16 v[52:53], v14 offset:3072
    ds_read_b64_tr_b16 v[54:55], v14 offset:3584
    s_waitcnt lgkmcnt(3)
    v_lshlrev_b32 v28, 16, v48
    v_fmac_f32 v208, v224, v28
    v_and_b32 v29, 0xffff0000, v48
    v_fmac_f32 v209, v225, v29
    v_lshlrev_b32 v28, 16, v49
    v_fmac_f32 v210, v226, v28
    v_and_b32 v29, 0xffff0000, v49
    v_fmac_f32 v211, v227, v29
    s_waitcnt lgkmcnt(2)
    v_lshlrev_b32 v28, 16, v50
    v_fmac_f32 v212, v228, v28
    v_and_b32 v29, 0xffff0000, v50
    v_fmac_f32 v213, v229, v29
    v_lshlrev_b32 v28, 16, v51
    v_fmac_f32 v214, v230, v28
    v_and_b32 v29, 0xffff0000, v51
    v_fmac_f32 v215, v231, v29
    s_waitcnt lgkmcnt(1)
    v_lshlrev_b32 v28, 16, v52
    v_fmac_f32 v216, v232, v28
    v_and_b32 v29, 0xffff0000, v52
    v_fmac_f32 v217, v233, v29
    v_lshlrev_b32 v28, 16, v53
    v_fmac_f32 v218, v234, v28
    v_and_b32 v29, 0xffff0000, v53
    v_fmac_f32 v219, v235, v29
    s_waitcnt lgkmcnt(0)
    v_lshlrev_b32 v28, 16, v54
    v_fmac_f32 v220, v236, v28
    v_and_b32 v29, 0xffff0000, v54
    v_fmac_f32 v221, v237, v29
    v_lshlrev_b32 v28, 16, v55
    v_fmac_f32 v222, v238, v28
    v_and_b32 v29, 0xffff0000, v55
    v_fmac_f32 v223, v239, v29
    v_pk_add_f32 v[208:209], v[208:209], v[72:73]
    v_pk_add_f32 v[210:211], v[210:211], v[74:75]
    v_pk_add_f32 v[212:213], v[212:213], v[76:77]
    v_pk_add_f32 v[214:215], v[214:215], v[78:79]
    v_pk_add_f32 v[216:217], v[216:217], v[80:81]
    v_pk_add_f32 v[218:219], v[218:219], v[82:83]
    v_pk_add_f32 v[220:221], v[220:221], v[84:85]
    v_pk_add_f32 v[222:223], v[222:223], v[86:87]
    v_pk_add_f32 v[208:209], v[208:209], v[88:89]
    v_pk_add_f32 v[210:211], v[210:211], v[90:91]
    v_pk_add_f32 v[212:213], v[212:213], v[92:93]
    v_pk_add_f32 v[214:215], v[214:215], v[94:95]
    v_pk_add_f32 v[216:217], v[216:217], v[96:97]
    v_pk_add_f32 v[218:219], v[218:219], v[98:99]
    v_pk_add_f32 v[220:221], v[220:221], v[100:101]
    v_pk_add_f32 v[222:223], v[222:223], v[102:103]
    v_pk_add_f32 v[208:209], v[208:209], v[104:105]
    v_pk_add_f32 v[210:211], v[210:211], v[106:107]
    v_cvt_pk_bf16_f32 v48, v208, v209
    v_cvt_pk_bf16_f32 v49, v210, v211
    v_pk_add_f32 v[212:213], v[212:213], v[108:109]
    v_pk_add_f32 v[214:215], v[214:215], v[110:111]
    v_cvt_pk_bf16_f32 v50, v212, v213
    v_cvt_pk_bf16_f32 v51, v214, v215
    v_pk_add_f32 v[216:217], v[216:217], v[112:113]
    v_pk_add_f32 v[218:219], v[218:219], v[114:115]
    v_cvt_pk_bf16_f32 v52, v216, v217
    v_cvt_pk_bf16_f32 v53, v218, v219
    v_pk_add_f32 v[220:221], v[220:221], v[116:117]
    v_pk_add_f32 v[222:223], v[222:223], v[118:119]
    v_cvt_pk_bf16_f32 v54, v220, v221
    v_cvt_pk_bf16_f32 v55, v222, v223
    ds_write_b64 v24, v[48:49]
    ds_write_b64 v25, v[50:51]
    ds_write_b64 v26, v[52:53]
    ds_write_b64 v27, v[54:55]
    ds_read_b128 v[56:59], v13
    ds_read_b128 v[60:63], v13 offset:1024
    s_waitcnt lgkmcnt(1)
    buffer_store_dwordx4 v[56:59], v11, s[72:75], 0 offen sc1
    s_waitcnt lgkmcnt(0)
    buffer_store_dwordx4 v[60:63], v12, s[72:75], 0 offen sc1
Lend:
    s_endpgm
Lslow_nonce:
    s_mov_b32 s99, 0
Lloop_nonce:
    s_sleep 1
    buffer_load_dwordx2 v[4:5], off, s[72:75], 0 sc1
    s_waitcnt vmcnt(0)
    v_cmp_eq_u64 vcc, 0, v[4:5]
    s_add_u32 s99, s99, 1
    s_cmp_ge_u32 s99, 20000
    s_cbranch_scc1 Lback_nonce
    s_nop 4
    s_cbranch_vccnz Lloop_nonce
    s_branch Lback_nonce
Lslow_stat:
    s_mov_b32 s99, 0
Lloop_stat:
    s_sleep 1
    buffer_load_dwordx4 v[184:187], v10, s[68:71], s87 offen offset:0 sc1
    buffer_load_dwordx4 v[188:191], v10, s[68:71], s87 offen offset:256 sc1
    buffer_load_dwordx4 v[192:195], v10, s[68:71], s87 offen offset:512 sc1
    buffer_load_dwordx4 v[196:199], v10, s[68:71], s87 offen offset:768 sc1
    s_waitcnt vmcnt(0)
    v_cmp_ne_u64 vcc, s[6:7], v[186:187]
    v_cmp_ne_u64 s[90:91], s[6:7], v[190:191]
    s_nop 0
    s_or_b64 vcc, vcc, s[90:91]
    v_cmp_ne_u64 s[90:91], s[6:7], v[194:195]
    s_nop 0
    s_or_b64 vcc, vcc, s[90:91]
    v_cmp_ne_u64 s[90:91], s[6:7], v[198:199]
    s_nop 0
    s_or_b64 vcc, vcc, s[90:91]
    s_add_u32 s99, s99, 1
    s_cmp_ge_u32 s99, 20000
    s_cbranch_scc1 Lback_stat
    s_nop 4
    s_cbranch_vccnz Lloop_stat
    s_branch Lback_stat
Lslow_est:
    s_mov_b32 s99, 0
Lloop_est:
    s_sleep 1
    buffer_load_dwordx4 v[30:33], v10, s[68:71], s87 offen sc1
    s_waitcnt vmcnt(0)
    v_cmp_ne_u64 vcc, s[6:7], v[32:33]
    s_add_u32 s99, s99, 1
    s_cmp_ge_u32 s99, 20000
    s_cbranch_scc1 Lback_est
    s_nop 4
    s_cbranch_vccnz Lloop_est
    s_branch Lback_est
Lslow_kv:
    s_mov_b32 s99, 0
Lloop_kv:
    s_sleep 1
    buffer_load_dwordx2 v[6:7], v8, s[68:71], 0 offen sc1
    s_waitcnt vmcnt(0)
    v_cmp_ne_u64 vcc, s[6:7], v[6:7]
    s_add_u32 s99, s99, 1
    s_cmp_ge_u32 s99, 20000
    s_cbranch_scc1 Lback_kv
    s_nop 4
    s_cbranch_vccnz Lloop_kv
    s_branch Lback_kv
Lslow_h:
    s_mov_b32 s99, 0
Lloop_h:
    s_sleep 1
    buffer_load_dwordx2 v[6:7], v8, s[68:71], 0 offen sc1
    s_waitcnt vmcnt(0)
    v_cmp_ne_u64 vcc, s[6:7], v[6:7]
    s_add_u32 s99, s99, 1
    s_cmp_ge_u32 s99, 20000
    s_cbranch_scc1 Lback_h
    s_nop 4
    s_cbranch_vccnz Lloop_h
    s_branch Lback_h
Lslow_h2:
    s_mov_b32 s99, 0
Lloop_h2:
    s_sleep 1
    buffer_load_dwordx2 v[6:7], v8, s[68:71], s97 offen sc1
    s_waitcnt vmcnt(0)
    v_cmp_ne_u64 vcc, s[6:7], v[6:7]
    s_add_u32 s99, s99, 1
    s_cmp_ge_u32 s99, 20000
    s_cbranch_scc1 Lback_h2
    s_nop 4
    s_cbranch_vccnz Lloop_h2
    s_branch Lback_h2
Lslow_y:
    s_mov_b32 s99, 0
Lloop_y:
    s_sleep 1
    buffer_load_dwordx2 v[6:7], v23, s[68:71], 0 offen sc1
    s_waitcnt vmcnt(0)
    v_cmp_ne_u64 vcc, s[6:7], v[6:7]
    s_add_u32 s99, s99, 1
    s_cmp_ge_u32 s99, 20000
    s_cbranch_scc1 Lback_y
    s_nop 4
    s_cbranch_vccnz Lloop_y
    s_branch Lback_y
Lcode_end:
    s_endpgm
.section .rodata,"a"
.p2align 6
.amdhsa_kernel parallel_sum__ssm_conv_h3__mixer_channel_mlp__prompt_kernel
  .amdhsa_next_free_vgpr 512
  .amdhsa_next_free_sgpr 102
  .amdhsa_accum_offset 256
  .amdhsa_group_segment_fixed_size 0
  .amdhsa_kernarg_size 112
  .amdhsa_user_sgpr_count 2
  .amdhsa_user_sgpr_kernarg_segment_ptr 1
  .amdhsa_system_sgpr_workgroup_id_x 1
.end_amdhsa_kernel
```
